```python
import torch

def _softmax(x, axis=-1):
    return torch.softmax(x, dim=axis)
def _gelu(x):
    return torch.nn.functional.gelu(x, approximate="tanh")
def _silu(x):
    return torch.nn.functional.silu(x)
def _sigmoid(x):
    return torch.sigmoid(x)
def _layernorm(x, axis=-1, eps=1e-5):
    m = x.mean(dim=axis, keepdim=True)
    v = x.var(dim=axis, keepdim=True, unbiased=False)
    return (x - m) / torch.sqrt(v + eps)
def _scatter_add(tgt, idx, src, axis=0):
    return tgt.clone().index_add_(axis, idx, src)
def _segment_sum(src, seg, n):
    out = torch.zeros((n,) + src.shape[1:], dtype=src.dtype)
    return out.index_add_(0, seg, src)
def _pad(x, pw):
    flat = tuple(v for pair in reversed(pw) for v in pair)
    return torch.nn.functional.pad(x, flat)

kernel_name = 'interleave_layers__sliding_block_cached__geglu_ffn__decode'

def setup_inputs():

    _w = (lambda a: (lambda t: t.to(torch.bfloat16) if t.is_floating_point() else t)(torch.as_tensor(a)))
    def _A_setup():
        B, Sq, D = 4, 1, 512
        Hq, Hkv, Sk, Dh = 32, 32, 4096, 128
        assert Hq % Hkv == 0, (Hq, Hkv)
        return {
            "x": _w((lambda *s: torch.randn(*s, dtype=torch.bfloat16) * 0.05)(B, Sq, D)),
            "k_cache": _w((lambda *s: torch.randn(*s, dtype=torch.bfloat16) * 1.6)(B, Hkv, Sk, Dh)),
            "v_cache": _w((lambda *s: torch.randn(*s, dtype=torch.bfloat16) * 1.6)(B, Hkv, Sk, Dh)),
            "wq": _w((lambda *s: torch.randn(*s, dtype=torch.bfloat16) * 1.6)(D, Hq * Dh) * (D ** -0.5)),
            "wo": _w((lambda *s: torch.randn(*s, dtype=torch.bfloat16) * 1.6)(Hq * Dh, D) * ((Hq * Dh) ** -0.5)),
        }
    _A_in = _A_setup()

    def _B_setup():
        B, S, D, F = 4, 1, 512, 1376
        return {
            "x": _w((lambda *s: torch.randn(*s, dtype=torch.bfloat16) * 0.05)(B, S, D)),
            "w_gate": _w((lambda *s: torch.randn(*s, dtype=torch.bfloat16) * 0.05)(D, F)),
            "w_up": _w((lambda *s: torch.randn(*s, dtype=torch.bfloat16) * 0.05)(D, F)),
            "w_down": _w((lambda *s: torch.randn(*s, dtype=torch.bfloat16) * 0.05)(F, D)),
        }
    _B_in = _B_setup()

    return {
        "A_x": _A_in["x"],
        "A_k_cache": _A_in["k_cache"],
        "A_v_cache": _A_in["v_cache"],
        "A_wq": _A_in["wq"],
        "A_wo": _A_in["wo"],
        "B_x": _B_in["x"],
        "B_w_gate": _B_in["w_gate"],
        "B_w_up": _B_in["w_up"],
        "B_w_down": _B_in["w_down"],
    }

def reference(A_x, A_k_cache, A_v_cache, A_wq, A_wo, B_x, B_w_gate, B_w_up, B_w_down):
    def _A_ref(x, k_cache, v_cache, wq, wo):
        B, Sq, D = x.shape
        Hq, Dh = 32, 128
        Hkv, Sk = k_cache.shape[1], k_cache.shape[2]
        W = min(4096, max(256, Sk // 4))
        rep = Hq // Hkv
        q = (lambda x, *d: x.permute(*d))((x @ wq).reshape(B, Sq, Hq, Dh), 0, 2, 1, 3)
        k = (lambda x, n, axis: torch.repeat_interleave(x, n, dim=axis))(k_cache[:, :, Sk - W:, :], rep, axis=1)
        v = (lambda x, n, axis: torch.repeat_interleave(x, n, dim=axis))(v_cache[:, :, Sk - W:, :], rep, axis=1)
        scores = torch.einsum("bhqd,bhkd->bhqk", q, k) * (Dh ** -0.5)
        p = _softmax(scores, axis=-1)
        o = torch.einsum("bhqk,bhkd->bhqd", p, v)
        return (lambda x, *d: x.permute(*d))(o, 0, 2, 1, 3).reshape(B, Sq, Hq * Dh) @ wo

    def _B_ref(x, w_gate, w_up, w_down):
        return (_gelu(x @ w_gate) * (x @ w_up)) @ w_down

    x = A_x
    x = x + _A_ref(_layernorm(x, axis=-1), A_k_cache, A_v_cache, A_wq, A_wo)
    x = x + _B_ref(_layernorm(x, axis=-1), B_w_gate, B_w_up, B_w_down)
    x = x + _A_ref(_layernorm(x, axis=-1), A_k_cache, A_v_cache, A_wq, A_wo)
    x = x + _B_ref(_layernorm(x, axis=-1), B_w_gate, B_w_up, B_w_down)
    return x
```

```asm
; @launch grid=(256,1,1) block=(256,1,1) lds=143104
.amdgcn_target "amdgcn-amd-amdhsa--gfx950"
.text
.globl interleave_layers__sliding_block_cached__geglu_ffn__decode_kernel
.p2align 8
.type interleave_layers__sliding_block_cached__geglu_ffn__decode_kernel,@function
interleave_layers__sliding_block_cached__geglu_ffn__decode_kernel:
    s_load_dwordx16 s[8:23], s[0:1], 0
    s_load_dwordx8 s[24:31], s[0:1], 64
    s_getpc_b64 s[84:85]
L_pc:
    v_lshlrev_b32 v36, 7, v0
    v_lshrrev_b32 v1, 6, v0
    v_min_u32 v36, L_end-L_pc, v36
    s_cmp_gt_u32 s2, 255
    s_cbranch_scc1 L_end
    global_load_dword v63, v36, s[84:85]
    v_readfirstlane_b32 s3, v1
    v_and_b32 v0, 63, v0
    s_and_b32 s4, s2, 7
    s_lshr_b32 s5, s2, 3
    s_and_b32 s78, s5, 3
    s_lshl2_add_u32 s78, s4, s78
    s_lshr_b32 s80, s5, 2
    s_and_b32 s73, s80, 3
    s_lshl_b32 s79, s73, 5
    s_add_u32 s79, s79, s78
    s_lshr_b32 s80, s5, 4
    s_lshl3_add_u32 s79, s79, s80
    s_add_u32 s79, s79, 6
    s_lshl_b32 s79, s79, 17
    v_lshlrev_b32 v32, 4, v0
    s_mov_b32 s35, 0x20000
    s_mov_b32 s34, s35
    s_lshl_b32 s77, s3, 12
    s_waitcnt lgkmcnt(0)
    s_add_u32 s32, s10, s79
    s_addc_u32 s33, s11, 0
    s_add_u32 s83, s77, 0
    buffer_load_dwordx4 a[0:3], v32, s[32:35], s83 offen offset:0 nt
    buffer_load_dwordx4 a[4:7], v32, s[32:35], s83 offen offset:1024 nt
    buffer_load_dwordx4 a[8:11], v32, s[32:35], s83 offen offset:2048 nt
    buffer_load_dwordx4 a[12:15], v32, s[32:35], s83 offen offset:3072 nt
    s_add_u32 s83, s77, 16384
    buffer_load_dwordx4 a[16:19], v32, s[32:35], s83 offen offset:0 nt
    buffer_load_dwordx4 a[20:23], v32, s[32:35], s83 offen offset:1024 nt
    buffer_load_dwordx4 a[24:27], v32, s[32:35], s83 offen offset:2048 nt
    v_bfe_u32 v38, v0, 3, 2
    v_and_b32 v39, 7, v0
    v_lshlrev_b32 v39, 7, v39
    v_lshl_add_u32 v40, v38, 13, v39
    s_lshl2_add_u32 s81, s5, s3
    s_lshl_b32 s82, s81, 15
    s_lshl_b32 s80, s4, 10
    s_add_u32 s82, s82, s80
    s_mov_b32 s43, s35
    s_mov_b32 s42, 0x400000
    s_mov_b32 s40, s14
    s_mov_b32 s41, s15
    buffer_load_dword v63, v40, s[40:43], s82 offen
    s_mov_b32 s38, s35
    s_mov_b32 s39, s35
    s_mov_b32 s47, s35
    s_mov_b32 s51, s35
    s_mov_b32 s55, s35
    s_mov_b32 s63, s35
    s_mov_b32 s67, s35
    s_mov_b32 s46, 0xC0000
    s_add_u32 s36, s12, s79
    s_addc_u32 s37, s13, 0
    s_mov_b32 s44, s30
    s_mov_b32 s45, s31
    s_cmp_lt_u32 s2, 32
    s_cbranch_scc1 L_clear
L_start:
    s_mov_b32 s71, 0
    s_cmp_lt_u32 s2, 32
    s_cbranch_scc1 L_probe
L_probed:
    buffer_load_dwordx4 a[28:31], v32, s[32:35], s83 offen offset:3072 nt
    s_getreg_b32 s91, hwreg(HW_REG_IB_STS, 8, 4)
    s_bitset1_b32 s71, s91
    v_lshrrev_b32 v41, 4, v0
    v_and_b32 v42, 15, v0
    v_and_b32 v43, 1, v41
    v_lshlrev_b32 v43, 1, v43
    v_xor_b32 v43, v43, v42
    s_lshl_b32 s80, s3, 2
    v_xor_b32 v43, s80, v43
    v_lshlrev_b32 v43, 4, v43
    v_add_u32 v47, s80, v41
    v_lshl_add_u32 v47, v47, 13, v43
    s_lshl_b32 s80, s78, 8
    v_add_u32 v47, s80, v47
    s_lshl_b32 s76, s3, 14
    s_lshl_b32 s82, s3, 10
    s_and_b32 s79, s78, 15
    s_lshl_b32 s79, s79, 2
    s_add_u32 s79, s79, s73
    s_lshr_b32 s80, s5, 4
    s_lshl_b32 s68, s79, 4
    s_add_u32 s68, s68, s80
    s_getreg_b32 s91, hwreg(HW_REG_IB_STS, 8, 4)
    s_bitset1_b32 s71, s91
    s_lshl_b32 s68, s68, 5
    s_andn2_b32 s69, s68, 8191
    s_add_u32 s68, s68, s69
    s_lshl_b32 s69, s79, 7
    s_lshl_b32 s80, s80, 2
    s_add_u32 s69, s69, s80
    s_add_u32 s69, s69, 131072
    s_and_b32 s74, s5, 1
    s_lshr_b32 s78, s5, 1
    s_mul_i32 s75, s4, 15
    s_add_u32 s75, s75, s78
    s_cmp_lt_u32 s75, 86
    s_cselect_b32 s6, 1, 0
    s_cmp_lt_u32 s5, 30
    s_cselect_b32 s6, s6, 0
    s_lshl_b32 s79, s4, 4
    s_add_u32 s79, s79, s78
    s_sub_u32 s79, s79, 96
    s_cmp_ge_u32 s4, 6
    s_cselect_b32 s6, 2, s6
    s_getreg_b32 s91, hwreg(HW_REG_IB_STS, 8, 4)
    s_bitset1_b32 s71, s91
    s_cselect_b32 s75, s79, s75
    v_lshrrev_b32 v43, 1, v42
    v_and_b32 v44, 1, v42
    v_lshlrev_b32 v45, 5, v41
    v_lshl_add_u32 v45, v44, 4, v45
    s_lshl_b32 s78, s73, 10
    v_add_u32 v8, s78, v32
    global_load_dwordx4 v[48:51], v8, s[8:9]
    s_getreg_b32 s91, hwreg(HW_REG_IB_STS, 8, 4)
    s_bitset1_b32 s71, s91
    v_and_b32 v17, 12, v42
    v_lshlrev_b32 v17, 7, v17
    v_lshl_add_u32 v17, v41, 6, v17
    v_and_b32 v46, 3, v42
    v_lshl_add_u32 v17, v46, 4, v17
    v_add_u32 v11, 131072, v45
    v_and_b32 v45, 2, v42
    v_lshlrev_b32 v45, 9, v45
    v_lshl_add_u32 v45, v44, 4, v45
    v_and_b32 v46, 12, v42
    v_lshl_add_u32 v45, v46, 3, v45
    v_and_b32 v46, 2, v41
    v_lshl_add_u32 v45, v46, 6, v45
    v_and_b32 v46, 1, v41
    v_lshl_add_u32 v45, v46, 3, v45
    s_lshl_b32 s78, s74, 11
    s_lshl_b32 s79, s3, 8
    s_add_u32 s79, s79, s78
    v_add_u32 v9, s79, v45
    global_load_dwordx2 v[6:7], v9, s[8:9]
    s_getreg_b32 s91, hwreg(HW_REG_IB_STS, 8, 4)
    s_bitset1_b32 s71, s91
    s_and_b32 s79, s75, 31
    s_lshl_b32 s79, s79, 5
    s_add_u32 s70, s79, s78
    v_lshlrev_b32 v45, 10, v46
    v_lshl_add_u32 v45, v42, 1, v45
    v_add_u32 v45, s70, v45
    global_load_ushort v4, v45, s[8:9]
    s_getreg_b32 s91, hwreg(HW_REG_IB_STS, 8, 4)
    s_bitset1_b32 s71, s91
    s_cmp_eq_u32 s6, 2
    s_cbranch_scc0 L_notouch
    global_load_ushort v63, v45, s[26:27]
    s_getreg_b32 s91, hwreg(HW_REG_IB_STS, 8, 4)
    s_bitset1_b32 s71, s91
L_notouch:
    v_mov_b32 v45, 0xBFF00
    buffer_load_dword v63, v45, s[44:47], 0 offen
    s_getreg_b32 s91, hwreg(HW_REG_IB_STS, 8, 4)
    s_bitset1_b32 s71, s91
    s_lshl_b32 s78, s3, 15
    buffer_load_dword v63, off, s[36:39], s78 nt
    s_getreg_b32 s91, hwreg(HW_REG_IB_STS, 8, 4)
    s_bitset1_b32 s71, s91
    v_mov_b32 v1, 0x4444
    v_mov_b32 v45, 0xeeee
    v_cmp_eq_u32 vcc, 1, v44
    s_nop 1
    v_cndmask_b32 v1, v1, v45, vcc
    s_mov_b32 s7, 0
    s_mov_b32 s59, -1
    s_lshr_b32 s72, s5, 2
    s_lshl_b32 s78, s4, 19
    s_mov_b32 s62, 0x80000
    s_add_u32 s60, s16, s78
    s_addc_u32 s61, s17, 0
    s_cmp_eq_u32 s6, 2
    s_cselect_b32 s48, s24, s20
    s_cselect_b32 s49, s25, s21
    s_cselect_b32 s52, s24, s22
    s_cselect_b32 s53, s25, s23
    s_mov_b32 s56, 88064
    s_cselect_b32 s56, 196608, s56
    s_mov_b32 s57, 176128
    s_cselect_b32 s57, 98304, s57
    s_getreg_b32 s91, hwreg(HW_REG_IB_STS, 8, 4)
    s_bitset1_b32 s71, s91
    s_cselect_b32 s58, 16384, 0
    s_mov_b32 s50, 1409024
    s_mov_b32 s54, s50
    s_mul_i32 s78, s74, 14336
    s_add_u32 s78, s78, 153600
    s_add_u32 s64, s30, s78
    s_addc_u32 s65, s31, 0
    s_mov_b32 s66, 12288
    s_mov_b32 s96, 0
    s_mov_b32 s97, 0
    s_mov_b32 s98, 0
    s_mov_b32 s99, 0
    s_add_u32 s83, s77, 32768
    buffer_load_dwordx4 a[32:35], v32, s[32:35], s83 offen offset:0 nt
    s_getreg_b32 s91, hwreg(HW_REG_IB_STS, 8, 4)
    s_bitset1_b32 s71, s91
    buffer_load_dwordx4 a[36:39], v32, s[32:35], s83 offen offset:1024 nt
    s_getreg_b32 s91, hwreg(HW_REG_IB_STS, 8, 4)
    s_bitset1_b32 s71, s91
    v_lshlrev_b32 v16, 2, v0
    v_mov_b32 v5, -2
    v_mov_b32 v28, 0x3f803f80
    v_mov_b32 v29, 0x3f803f80
    v_mov_b32 v30, 0x3f803f80
    v_mov_b32 v31, 0x3f803f80
    v_and_b32 v44, 1, v42
    v_and_b32 v43, 2, v42
    v_lshlrev_b32 v43, 3, v43
    v_and_b32 v45, 12, v42
    v_add_u32 v43, v43, v45
    v_lshl_add_u32 v43, v44, 1, v43
    v_and_b32 v45, 32, v0
    v_add_u32 v43, v43, v45
    s_lshl_b32 s78, s3, 6
    s_add_u32 s78, s78, 131072
    v_add_u32 v10, s78, v43
    s_lshl_b32 s78, s3, 10
    s_add_u32 s78, s78, 131328
    v_lshl_add_u32 v12, v0, 3, s78
    s_getreg_b32 s91, hwreg(HW_REG_IB_STS, 8, 4)
    s_bitset1_b32 s71, s91
    v_lshl_add_u32 v12, v41, 5, v12
    s_lshl_b32 s78, s3, 9
    s_add_u32 s78, s78, 135424
    v_lshl_add_u32 v13, v0, 3, s78
    v_lshlrev_b32 v43, 3, v0
    v_add_u32 v35, s76, v43
    v_and_b32 v43, 3, v0
    v_mul_u32_u24 v43, 160, v43
    v_lshrrev_b32 v45, 2, v0
    v_lshl_add_u32 v43, v45, 3, v43
    v_add_u32 v14, 131328, v43
    v_mov_b32 v15, 135928
    s_and_b32 s78, s4, 3
    s_lshl_b32 s78, s78, 2
    s_add_u32 s78, s78, s3
    s_lshl_b32 s79, s78, 11
    s_andn2_b32 s80, s79, 8191
    s_add_u32 s79, s79, s80
    v_add_u32 v17, s79, v17
    s_lshl_b32 s79, s78, 9
    s_getreg_b32 s91, hwreg(HW_REG_IB_STS, 8, 4)
    s_bitset1_b32 s71, s91
    s_andn2_b32 s80, s79, 8191
    s_add_u32 s79, s79, s80
    s_add_u32 s79, s79, 131072
    v_lshl_add_u32 v18, v41, 7, s79
    v_add_u32 v20, 137472, v16
    s_lshl_b32 s78, s3, 8
    v_add_u32 v19, s78, v20
    v_bfe_u32 v43, v0, 3, 2
    v_lshlrev_b32 v43, 4, v43
    v_lshrrev_b32 v45, 5, v0
    v_lshl_add_u32 v46, v45, 13, v43
    v_lshl_add_u32 v45, v45, 15, v43
    v_mov_b32 v43, v46
    s_lshl_b32 s78, s4, 5
    s_add_u32 s78, s78, s5
    s_lshl_b32 s78, s78, 6
    s_andn2_b32 s80, s78, 8191
    s_add_u32 s78, s78, s80
    s_add_u32 s78, s78, 65536
    v_add_u32 v21, s78, v45
    s_getreg_b32 s91, hwreg(HW_REG_IB_STS, 8, 4)
    s_bitset1_b32 s71, s91
    v_bfe_u32 v45, v0, 1, 1
    v_bfe_u32 v46, v0, 5, 1
    v_lshl_add_u32 v45, v46, 1, v45
    v_bfe_u32 v46, v0, 2, 1
    v_lshl_add_u32 v45, v46, 3, v45
    v_bfe_u32 v46, v0, 3, 1
    v_bfe_u32 v36, v0, 4, 1
    v_lshl_add_u32 v37, v46, 2, v45
    v_lshl_add_u32 v37, v36, 4, v37
    v_lshl_add_u32 v45, v46, 4, v45
    v_lshl_add_u32 v45, v36, 2, v45
    v_lshlrev_b32 v44, 4, v44
    v_lshl_add_u32 v37, v37, 10, v44
    s_lshl_b32 s78, s3, 17
    s_lshl_b32 s79, s5, 5
    s_add_u32 s78, s78, s79
    v_add_u32 v33, s78, v37
    s_lshl_b32 s79, s75, 5
    s_cmp_eq_u32 s6, 2
    s_cbranch_scc1 L_setG
    s_getreg_b32 s91, hwreg(HW_REG_IB_STS, 8, 4)
    s_bitset1_b32 s71, s91
    s_movk_i32 s78, 2752
    v_mad_u32_u24 v45, v45, s78, v44
    s_mul_i32 s78, s3, 352256
    s_add_u32 s78, s78, s79
    s_cmp_eq_u32 s6, 0
    s_cselect_b32 s78, 0x1000000, s78
    v_add_u32 v34, s78, v45
    s_lshl_b32 s78, s74, 15
    s_lshl_b32 s79, s3, 9
    s_add_u32 s78, s78, s79
    s_add_u32 s78, s78, 65536
    v_lshlrev_b32 v45, 11, v41
    v_lshl_add_u32 v45, v42, 4, v45
    v_add_u32 v22, s78, v45
    s_add_u32 s79, s79, 138496
    v_lshl_add_u32 v23, v0, 3, s79
    v_and_b32 v45, 2, v0
    v_lshlrev_b32 v45, 4, v45
    v_lshrrev_b32 v46, 5, v0
    v_lshl_add_u32 v45, v46, 2, v45
    s_getreg_b32 s91, hwreg(HW_REG_IB_STS, 8, 4)
    s_bitset1_b32 s71, s91
    s_lshl_b32 s78, s3, 3
    s_add_u32 s78, s78, 140544
    v_add_u32 v45, s78, v45
    v_and_b32 v46, 29, v0
    v_cmp_eq_u32 vcc, 0, v46
    v_add_u32 v46, 140672, v16
    s_nop 0
    v_cndmask_b32 v24, v46, v45, vcc
    v_and_b32 v46, 1, v41
    v_lshlrev_b32 v45, 8, v46
    v_lshl_add_u32 v45, v42, 3, v45
    v_add_u32 v25, 138496, v45
    v_lshlrev_b32 v45, 5, v46
    v_add_u32 v26, 140544, v45
    s_lshl_b32 s78, s74, 8
    s_add_u32 s78, s78, s75
    s_lshl_b32 s78, s78, 6
    s_add_u32 s78, s78, 147456
    s_cmp_eq_u32 s6, 0
    s_cselect_b32 s78, 0x1000000, s78
    v_add_u32 v27, s78, v43
    s_getreg_b32 s91, hwreg(HW_REG_IB_STS, 8, 4)
    s_bitset1_b32 s71, s91
    s_branch L_setD
L_setG:
    s_mul_i32 s78, s3, 393216
    s_add_u32 s78, s78, s79
    v_add_u32 v34, s78, v37
    v_lshl_add_u32 v34, v36, 15, v34
    s_lshl_b32 s78, s74, 8
    s_mul_i32 s79, s3, 24
    s_add_u32 s78, s78, s79
    s_lshl_b32 s78, s78, 6
    s_add_u32 s78, s78, 147456
    v_mul_u32_u24 v45, 192, v41
    v_lshl_add_u32 v45, v42, 4, v45
    v_add_u32 v22, s78, v45
    s_lshl_b32 s78, s3, 8
    s_add_u32 s78, s78, 142080
    v_lshl_add_u32 v23, v42, 2, s78
    v_and_b32 v45, 16, v0
    v_lshl_add_u32 v23, v45, 3, v23
    v_and_b32 v45, 32, v0
    v_lshl_add_u32 v23, v45, 1, v23
    v_and_b32 v46, 1, v41
    s_getreg_b32 s91, hwreg(HW_REG_IB_STS, 8, 4)
    s_bitset1_b32 s71, s91
    v_lshlrev_b32 v45, 6, v46
    v_lshl_add_u32 v45, v42, 2, v45
    v_add_u32 v24, 142080, v45
    v_lshrrev_b32 v45, 3, v42
    v_lshlrev_b32 v45, 4, v45
    v_lshl_add_u32 v25, v46, 10, v45
    v_and_b32 v45, 32, v0
    v_lshl_add_u32 v25, v45, 8, v25
    s_lshl_b32 s78, s74, 15
    s_lshl_b32 s79, s75, 6
    s_add_u32 s78, s78, s79
    s_add_u32 s78, s78, 65536
    v_lshrrev_b32 v45, 1, v42
    v_lshlrev_b32 v45, 2, v45
    v_lshl_add_u32 v45, v46, 5, v45
    v_add_u32 v26, s78, v45
    v_mov_b32 v45, 0x3f80
    v_lshlrev_b32 v27, v44, v45
L_setD:
    buffer_load_dwordx4 a[40:43], v32, s[32:35], s83 offen offset:2048 nt
    buffer_load_dwordx4 a[44:47], v32, s[32:35], s83 offen offset:3072 nt
    s_barrier
    s_add_u32 s83, s77, 49152
    buffer_load_dwordx4 a[48:51], v32, s[32:35], s83 offen offset:0 nt
    s_bitcmp1_b32 1, s73
    s_cbranch_scc0 L_W13
    s_call_b64 s[0:1], L_Wburst
L_W13:
    buffer_load_dwordx4 a[52:55], v32, s[32:35], s83 offen offset:1024 nt
    buffer_load_dwordx4 a[56:59], v32, s[32:35], s83 offen offset:2048 nt
    buffer_load_dwordx4 a[60:63], v32, s[32:35], s83 offen offset:3072 nt
    s_barrier
    s_add_u32 s83, s77, 65536
    buffer_load_dwordx4 a[64:67], v32, s[32:35], s83 offen offset:0 nt
    buffer_load_dwordx4 a[68:71], v32, s[32:35], s83 offen offset:1024 nt
    buffer_load_dwordx4 a[72:75], v32, s[32:35], s83 offen offset:2048 nt
    s_bitcmp1_b32 2, s73
    s_cbranch_scc0 L_W19
    s_call_b64 s[0:1], L_Wburst
L_W19:
    buffer_load_dwordx4 a[76:79], v32, s[32:35], s83 offen offset:3072 nt
    s_barrier
    s_add_u32 s83, s77, 81920
    buffer_load_dwordx4 a[80:83], v32, s[32:35], s83 offen offset:0 nt
    buffer_load_dwordx4 a[84:87], v32, s[32:35], s83 offen offset:1024 nt
    buffer_load_dwordx4 a[88:91], v32, s[32:35], s83 offen offset:2048 nt
    buffer_load_dwordx4 a[92:95], v32, s[32:35], s83 offen offset:3072 nt
    s_barrier
    s_add_u32 s83, s77, 98304
    buffer_load_dwordx4 a[96:99], v32, s[32:35], s83 offen offset:0 nt
    s_bitcmp1_b32 4, s73
    s_cbranch_scc0 L_W25
    s_call_b64 s[0:1], L_Wburst
L_W25:
    s_bitcmp1_b32 1, s73
    s_cbranch_scc0 L_C25
    s_call_b64 s[0:1], L_consume
L_C25:
    buffer_load_dwordx4 a[100:103], v32, s[32:35], s83 offen offset:1024 nt
    buffer_load_dwordx4 a[104:107], v32, s[32:35], s83 offen offset:2048 nt
    buffer_load_dwordx4 a[108:111], v32, s[32:35], s83 offen offset:3072 nt
    s_barrier
    s_add_u32 s83, s77, 114688
    buffer_load_dwordx4 a[112:115], v32, s[32:35], s83 offen offset:0 nt
    buffer_load_dwordx4 a[116:119], v32, s[32:35], s83 offen offset:1024 nt
    buffer_load_dwordx4 a[120:123], v32, s[32:35], s83 offen offset:2048 nt
    s_bitcmp1_b32 2, s73
    s_cbranch_scc0 L_C31
    s_call_b64 s[0:1], L_consume
L_C31:
    buffer_load_dwordx4 a[124:127], v32, s[32:35], s83 offen offset:3072 nt
    s_barrier
    s_bitcmp1_b32 8, s73
    s_cbranch_scc0 L_W32
    s_call_b64 s[0:1], L_Wburst
L_W32:
    s_add_u32 s83, s77, 0
    buffer_load_dwordx4 v[132:135], v32, s[36:39], s83 offen offset:0 nt
    buffer_load_dwordx4 v[140:143], v32, s[36:39], s83 offen offset:1024 nt
    buffer_load_dwordx4 v[148:151], v32, s[36:39], s83 offen offset:2048 nt
    buffer_load_dwordx4 v[156:159], v32, s[36:39], s83 offen offset:3072 nt
    s_barrier
    s_add_u32 s83, s77, 16384
    buffer_load_dwordx4 v[164:167], v32, s[36:39], s83 offen offset:0 nt
    s_bitcmp1_b32 4, s73
    s_cbranch_scc0 L_C37
    s_call_b64 s[0:1], L_consume
L_C37:
    buffer_load_dwordx4 v[172:175], v32, s[36:39], s83 offen offset:1024 nt
    buffer_load_dwordx4 v[180:183], v32, s[36:39], s83 offen offset:2048 nt
    buffer_load_dwordx4 v[188:191], v32, s[36:39], s83 offen offset:3072 nt
    s_barrier
    s_add_u32 s83, s77, 32768
    buffer_load_dwordx4 v[192:195], v32, s[36:39], s83 offen offset:0 nt
    buffer_load_dwordx4 v[200:203], v32, s[36:39], s83 offen offset:1024 nt
    buffer_load_dwordx4 v[208:211], v32, s[36:39], s83 offen offset:2048 nt
    buffer_load_dwordx4 v[216:219], v32, s[36:39], s83 offen offset:3072 nt
    s_bitcmp1_b32 8, s73
    s_cbranch_scc0 L_C44
    s_call_b64 s[0:1], L_consume
L_C44:
    v_and_b32 v47, 15, v0
    v_lshrrev_b32 v46, 4, v0
    s_add_u32 s79, s76, 0x10000
    v_and_b32 v48, 1, v46
    v_lshlrev_b32 v48, 3, v48
    v_xor_b32 v48, v48, v47
    v_lshlrev_b32 v48, 4, v48
    v_lshl_add_u32 v48, v46, 8, v48
    v_add_u32 v48, s79, v48
    v_and_b32 v49, 4, v47
    v_and_b32 v50, 1, v47
    v_lshl_add_u32 v49, v50, 1, v49
    v_bfe_u32 v50, v47, 1, 1
    v_add_u32 v49, v49, v50
    v_lshrrev_b32 v50, 3, v47
    v_lshl_add_u32 v49, v49, 2, v50
    v_xor_b32 v50, v46, v47
    v_lshlrev_b32 v50, 4, v50
    v_lshl_add_u32 v49, v49, 8, v50
    v_add_u32 v49, s79, v49
    s_waitcnt vmcnt(12)
    v_xor_b32 v50, 0, v48
    ds_write_b128 v50, a[0:3] offset:0
    ds_write_b128 v50, a[32:35] offset:8192
    v_xor_b32 v50, 32, v48
    ds_write_b128 v50, a[4:7] offset:1024
    ds_write_b128 v50, a[36:39] offset:9216
    s_add_u32 s83, s77, 49152
    buffer_load_dwordx4 v[224:227], v32, s[36:39], s83 offen offset:0 nt
    v_xor_b32 v50, 16, v48
    ds_write_b128 v50, a[8:11] offset:2048
    ds_write_b128 v50, a[40:43] offset:10240
    v_xor_b32 v50, 48, v48
    ds_write_b128 v50, a[12:15] offset:3072
    ds_write_b128 v50, a[44:47] offset:11264
    buffer_load_dwordx4 v[232:235], v32, s[36:39], s83 offen offset:1024 nt
    v_xor_b32 v50, 64, v48
    ds_write_b128 v50, a[16:19] offset:4096
    ds_write_b128 v50, a[48:51] offset:12288
    v_xor_b32 v50, 96, v48
    ds_write_b128 v50, a[20:23] offset:5120
    ds_write_b128 v50, a[52:55] offset:13312
    buffer_load_dwordx4 v[240:243], v32, s[36:39], s83 offen offset:2048 nt
    v_xor_b32 v50, 80, v48
    ds_write_b128 v50, a[24:27] offset:6144
    ds_write_b128 v50, a[56:59] offset:14336
    v_xor_b32 v50, 112, v48
    ds_write_b128 v50, a[28:31] offset:7168
    ds_write_b128 v50, a[60:63] offset:15360
    buffer_load_dwordx4 v[248:251], v32, s[36:39], s83 offen offset:3072 nt
    s_waitcnt lgkmcnt(0)
    v_xor_b32 v50, 0, v49
    ds_read_b128 a[0:3], v50 offset:0
    ds_read_b128 a[16:19], v50 offset:512
    ds_read_b128 a[32:35], v50 offset:8192
    ds_read_b128 a[48:51], v50 offset:8704
    v_xor_b32 v50, 64, v49
    ds_read_b128 a[4:7], v50 offset:0
    ds_read_b128 a[20:23], v50 offset:512
    ds_read_b128 a[36:39], v50 offset:8192
    ds_read_b128 a[52:55], v50 offset:8704
    s_barrier
    s_add_u32 s83, s77, 65536
    buffer_load_dwordx4 v[196:199], v32, s[36:39], s83 offen offset:0 nt
    v_xor_b32 v50, 128, v49
    ds_read_b128 a[8:11], v50 offset:0
    ds_read_b128 a[24:27], v50 offset:512
    ds_read_b128 a[40:43], v50 offset:8192
    ds_read_b128 a[56:59], v50 offset:8704
    v_xor_b32 v50, 192, v49
    ds_read_b128 a[12:15], v50 offset:0
    ds_read_b128 a[28:31], v50 offset:512
    ds_read_b128 a[44:47], v50 offset:8192
    ds_read_b128 a[60:63], v50 offset:8704
    buffer_load_dwordx4 v[204:207], v32, s[36:39], s83 offen offset:1024 nt
    s_waitcnt lgkmcnt(0)
    v_xor_b32 v50, 0, v48
    ds_write_b128 v50, a[64:67] offset:0
    ds_write_b128 v50, a[96:99] offset:8192
    v_xor_b32 v50, 32, v48
    ds_write_b128 v50, a[68:71] offset:1024
    ds_write_b128 v50, a[100:103] offset:9216
    buffer_load_dwordx4 v[212:215], v32, s[36:39], s83 offen offset:2048 nt
    v_xor_b32 v50, 16, v48
    ds_write_b128 v50, a[72:75] offset:2048
    ds_write_b128 v50, a[104:107] offset:10240
    v_xor_b32 v50, 48, v48
    ds_write_b128 v50, a[76:79] offset:3072
    ds_write_b128 v50, a[108:111] offset:11264
    buffer_load_dwordx4 v[220:223], v32, s[36:39], s83 offen offset:3072 nt
    v_xor_b32 v50, 64, v48
    ds_write_b128 v50, a[80:83] offset:4096
    ds_write_b128 v50, a[112:115] offset:12288
    v_xor_b32 v50, 96, v48
    ds_write_b128 v50, a[84:87] offset:5120
    ds_write_b128 v50, a[116:119] offset:13312
    s_barrier
    s_add_u32 s83, s77, 81920
    buffer_load_dwordx4 v[228:231], v32, s[36:39], s83 offen offset:0 nt
    v_xor_b32 v50, 80, v48
    ds_write_b128 v50, a[88:91] offset:6144
    ds_write_b128 v50, a[120:123] offset:14336
    v_xor_b32 v50, 112, v48
    ds_write_b128 v50, a[92:95] offset:7168
    ds_write_b128 v50, a[124:127] offset:15360
    buffer_load_dwordx4 v[236:239], v32, s[36:39], s83 offen offset:1024 nt
    s_waitcnt lgkmcnt(0)
    v_xor_b32 v50, 0, v49
    ds_read_b128 a[64:67], v50 offset:0
    ds_read_b128 a[80:83], v50 offset:512
    ds_read_b128 a[96:99], v50 offset:8192
    ds_read_b128 a[112:115], v50 offset:8704
    v_xor_b32 v50, 64, v49
    ds_read_b128 a[68:71], v50 offset:0
    ds_read_b128 a[84:87], v50 offset:512
    ds_read_b128 a[100:103], v50 offset:8192
    ds_read_b128 a[116:119], v50 offset:8704
    buffer_load_dwordx4 v[244:247], v32, s[36:39], s83 offen offset:2048 nt
    v_xor_b32 v50, 128, v49
    ds_read_b128 a[72:75], v50 offset:0
    ds_read_b128 a[88:91], v50 offset:512
    ds_read_b128 a[104:107], v50 offset:8192
    ds_read_b128 a[120:123], v50 offset:8704
    v_xor_b32 v50, 192, v49
    ds_read_b128 a[76:79], v50 offset:0
    ds_read_b128 a[92:95], v50 offset:512
    ds_read_b128 a[108:111], v50 offset:8192
    ds_read_b128 a[124:127], v50 offset:8704
    buffer_load_dwordx4 v[252:255], v32, s[36:39], s83 offen offset:3072 nt
    s_waitcnt lgkmcnt(0)
    s_branch L_QK
L_consume:
    v_bfe_u32 v43, v0, 2, 1
    v_bfe_u32 v44, v0, 3, 1
    v_bfe_u32 v45, v0, 4, 1
    v_bfe_u32 v46, v0, 5, 1
    v_lshl_add_u32 v36, v45, 2, v43
    v_lshl_add_u32 v36, v44, 3, v36
    v_lshl_add_u32 v36, v46, 7, v36
    v_lshl_add_u32 v37, v45, 1, v43
    v_lshl_add_u32 v37, v44, 2, v37
    s_lshl_b32 s78, s3, 1
    v_xor_b32 v37, s78, v37
    v_lshlrev_b32 v36, 8, v36
    v_lshl_add_u32 v36, v37, 5, v36
    v_and_b32 v37, 3, v0
    v_lshl_add_u32 v43, v37, 3, v36
    v_add_u32 v44, 0x10000, v43
    v_xor_b32 v45, 32, v43
    v_xor_b32 v46, 32, v44
    v_mov_b64 v[52:53], 0
    v_mov_b64 v[56:57], 0
    v_mov_b64 v[64:65], 0
    v_mov_b64 v[70:71], 0
    v_mov_b64 v[72:73], 0
    v_mov_b64 v[78:79], 0
    v_mov_b64 v[80:81], 0
    v_mov_b64 v[86:87], 0
    v_mov_b64 v[88:89], 0
    v_mov_b64 v[94:95], 0
    v_mov_b64 v[96:97], 0
    v_mov_b64 v[102:103], 0
    v_mov_b64 v[104:105], 0
    v_mov_b64 v[110:111], 0
    v_mov_b64 v[112:113], 0
    v_mov_b64 v[118:119], 0
    v_mov_b64 v[120:121], 0
    v_mov_b64 v[126:127], 0
    s_cmp_lt_u32 s2, 32
    s_waitcnt vmcnt(12)
    s_barrier
    s_cbranch_scc1 L_flag
L_flagged:
    v_mov_b32 v36, v48
    v_mov_b32 v37, v49
    v_mov_b32 v38, v50
    v_mov_b32 v39, v51
    v_lshlrev_b32 v4, 16, v4
    ds_read_b64_tr_b16 a[128:129], v43 offset:0
    ds_read_b64_tr_b16 a[130:131], v43 offset:512
    ds_read_b64_tr_b16 a[132:133], v44 offset:0
    ds_read_b64_tr_b16 a[134:135], v44 offset:512
    ds_read_b64_tr_b16 a[192:193], v45 offset:0
    ds_read_b64_tr_b16 a[194:195], v45 offset:512
    ds_read_b64_tr_b16 a[196:197], v46 offset:0
    ds_read_b64_tr_b16 a[198:199], v46 offset:512
    ds_read_b64_tr_b16 a[136:137], v43 offset:4096
    ds_read_b64_tr_b16 a[138:139], v43 offset:4608
    ds_read_b64_tr_b16 a[140:141], v44 offset:4096
    ds_read_b64_tr_b16 a[142:143], v44 offset:4608
    ds_read_b64_tr_b16 a[200:201], v45 offset:4096
    ds_read_b64_tr_b16 a[202:203], v45 offset:4608
    ds_read_b64_tr_b16 a[204:205], v46 offset:4096
    ds_read_b64_tr_b16 a[206:207], v46 offset:4608
    ds_read_b64_tr_b16 a[144:145], v43 offset:8192
    ds_read_b64_tr_b16 a[146:147], v43 offset:8704
    ds_read_b64_tr_b16 a[148:149], v44 offset:8192
    ds_read_b64_tr_b16 a[150:151], v44 offset:8704
    ds_read_b64_tr_b16 a[208:209], v45 offset:8192
    ds_read_b64_tr_b16 a[210:211], v45 offset:8704
    ds_read_b64_tr_b16 a[212:213], v46 offset:8192
    ds_read_b64_tr_b16 a[214:215], v46 offset:8704
    ds_read_b64_tr_b16 a[152:153], v43 offset:12288
    ds_read_b64_tr_b16 a[154:155], v43 offset:12800
    ds_read_b64_tr_b16 a[156:157], v44 offset:12288
    ds_read_b64_tr_b16 a[158:159], v44 offset:12800
    ds_read_b64_tr_b16 a[216:217], v45 offset:12288
    ds_read_b64_tr_b16 a[218:219], v45 offset:12800
    ds_read_b64_tr_b16 a[220:221], v46 offset:12288
    ds_read_b64_tr_b16 a[222:223], v46 offset:12800
    ds_read_b64_tr_b16 a[160:161], v43 offset:16384
    ds_read_b64_tr_b16 a[162:163], v43 offset:16896
    ds_read_b64_tr_b16 a[164:165], v44 offset:16384
    ds_read_b64_tr_b16 a[166:167], v44 offset:16896
    ds_read_b64_tr_b16 a[224:225], v45 offset:16384
    ds_read_b64_tr_b16 a[226:227], v45 offset:16896
    ds_read_b64_tr_b16 a[228:229], v46 offset:16384
    ds_read_b64_tr_b16 a[230:231], v46 offset:16896
    ds_read_b64_tr_b16 a[168:169], v43 offset:20480
    ds_read_b64_tr_b16 a[170:171], v43 offset:20992
    ds_read_b64_tr_b16 a[172:173], v44 offset:20480
    ds_read_b64_tr_b16 a[174:175], v44 offset:20992
    ds_read_b64_tr_b16 a[232:233], v45 offset:20480
    ds_read_b64_tr_b16 a[234:235], v45 offset:20992
    ds_read_b64_tr_b16 a[236:237], v46 offset:20480
    ds_read_b64_tr_b16 a[238:239], v46 offset:20992
    ds_read_b64_tr_b16 a[176:177], v43 offset:24576
    ds_read_b64_tr_b16 a[178:179], v43 offset:25088
    ds_read_b64_tr_b16 a[180:181], v44 offset:24576
    ds_read_b64_tr_b16 a[182:183], v44 offset:25088
    ds_read_b64_tr_b16 a[240:241], v45 offset:24576
    ds_read_b64_tr_b16 a[242:243], v45 offset:25088
    ds_read_b64_tr_b16 a[244:245], v46 offset:24576
    ds_read_b64_tr_b16 a[246:247], v46 offset:25088
    ds_read_b64_tr_b16 a[184:185], v43 offset:28672
    ds_read_b64_tr_b16 a[186:187], v43 offset:29184
    ds_read_b64_tr_b16 a[188:189], v44 offset:28672
    ds_read_b64_tr_b16 a[190:191], v44 offset:29184
    ds_read_b64_tr_b16 a[248:249], v45 offset:28672
    ds_read_b64_tr_b16 a[250:251], v45 offset:29184
    ds_read_b64_tr_b16 a[252:253], v46 offset:28672
    ds_read_b64_tr_b16 a[254:255], v46 offset:29184
    s_waitcnt lgkmcnt(0)
    v_smfmac_f32_16x16x64_bf16 v[52:55], v[28:31], a[128:135], v1
    v_smfmac_f32_16x16x64_bf16 v[56:59], v[28:31], a[192:199], v1
    v_smfmac_f32_16x16x64_bf16 v[52:55], v[28:31], a[136:143], v1
    v_smfmac_f32_16x16x64_bf16 v[56:59], v[28:31], a[200:207], v1
    v_smfmac_f32_16x16x64_bf16 v[52:55], v[28:31], a[144:151], v1
    v_smfmac_f32_16x16x64_bf16 v[56:59], v[28:31], a[208:215], v1
    v_smfmac_f32_16x16x64_bf16 v[52:55], v[28:31], a[152:159], v1
    v_smfmac_f32_16x16x64_bf16 v[56:59], v[28:31], a[216:223], v1
    v_smfmac_f32_16x16x64_bf16 v[52:55], v[28:31], a[160:167], v1
    v_smfmac_f32_16x16x64_bf16 v[56:59], v[28:31], a[224:231], v1
    v_smfmac_f32_16x16x64_bf16 v[52:55], v[28:31], a[168:175], v1
    v_smfmac_f32_16x16x64_bf16 v[56:59], v[28:31], a[232:239], v1
    v_smfmac_f32_16x16x64_bf16 v[52:55], v[28:31], a[176:183], v1
    v_smfmac_f32_16x16x64_bf16 v[56:59], v[28:31], a[240:247], v1
    v_smfmac_f32_16x16x64_bf16 v[52:55], v[28:31], a[184:191], v1
    v_smfmac_f32_16x16x64_bf16 v[56:59], v[28:31], a[248:255], v1
    s_nop 6
    v_add_f32 v2, v52, v53
    v_mul_f32 v2, 0xbb000000, v2
    v_add_f32 v3, v56, v57
    v_mul_f32 v3, 0xbb000000, v3
    s_branch L_S1
L_D:
    s_lshr_b32 s79, s73, 1
    s_mul_i32 s79, s79, 14336
    s_add_u32 s79, s79, s35
    s_add_u32 s79, s79, 153600
    s_barrier
    s_sleep 7
    buffer_load_dwordx4 v[36:39], v8, s[44:47], s79 offen sc1
    v_mov_b64 v[64:65], 0
    v_mov_b64 v[70:71], 0
    v_mov_b64 v[72:73], 0
    v_mov_b64 v[78:79], 0
    v_mov_b64 v[80:81], 0
    v_mov_b64 v[86:87], 0
    v_mov_b64 v[88:89], 0
    v_mov_b64 v[94:95], 0
    v_mov_b64 v[96:97], 0
    v_mov_b64 v[102:103], 0
    v_mov_b64 v[104:105], 0
    v_mov_b64 v[110:111], 0
    v_mov_b64 v[112:113], 0
    v_mov_b64 v[118:119], 0
    v_mov_b64 v[120:121], 0
    v_mov_b64_e64 v[126:127], 0
    s_mul_i32 s34, s74, 14336
    s_add_u32 s34, s34, s35
    s_add_u32 s34, s34, 153600
    s_mov_b32 s7, 180224
    s_mov_b32 s59, -2
    s_add_u32 s39, s35, 180224
    s_movk_i32 s66, 4096
    s_add_u32 s68, s68, 180224
    s_add_u32 s69, s69, 180224
    s_mov_b32 s64, s26
    s_mov_b32 s65, s27
    s_waitcnt vmcnt(0)
L_S1:
    v_mfma_f32_16x16x32_bf16 v[40:43], v[36:39], v[28:31], 0
    v_smfmac_f32_16x16x64_bf16 v[64:67], v[36:39], a[128:135], v1
    v_smfmac_f32_16x16x64_bf16 v[96:99], v[36:39], a[192:199], v1
    v_smfmac_f32_16x16x64_bf16 v[68:71], v[36:39], a[136:143], v1
    v_smfmac_f32_16x16x64_bf16 v[100:103], v[36:39], a[200:207], v1
    v_smfmac_f32_16x16x64_bf16 v[72:75], v[36:39], a[144:151], v1
    v_smfmac_f32_16x16x64_bf16 v[104:107], v[36:39], a[208:215], v1
    v_smfmac_f32_16x16x64_bf16 v[76:79], v[36:39], a[152:159], v1
    s_nop 0
    v_pk_add_f32 v[40:41], v[40:41], v[42:43]
    v_smfmac_f32_16x16x64_bf16 v[108:111], v[36:39], a[216:223], v1
    v_add_f32_dpp v46, v64, v65 quad_perm:[0,1,2,3] row_mask:0x1 bank_mask:0xf
    v_add_f32_dpp v47, v96, v97 quad_perm:[0,1,2,3] row_mask:0x1 bank_mask:0xf
    v_smfmac_f32_16x16x64_bf16 v[80:83], v[36:39], a[160:167], v1
    v_add_f32_dpp v48, v70, v71 quad_perm:[0,1,2,3] row_mask:0x1 bank_mask:0xf
    v_add_f32_dpp v49, v102, v103 quad_perm:[0,1,2,3] row_mask:0x1 bank_mask:0xf
    v_smfmac_f32_16x16x64_bf16 v[112:115], v[36:39], a[224:231], v1
    v_add_f32_dpp v46, v72, v73 quad_perm:[0,1,2,3] row_mask:0x2 bank_mask:0xf
    v_smfmac_f32_16x16x64_bf16 v[84:87], v[36:39], a[168:175], v1
    v_add_f32_dpp v47, v104, v105 quad_perm:[0,1,2,3] row_mask:0x2 bank_mask:0xf
    v_smfmac_f32_16x16x64_bf16 v[116:119], v[36:39], a[232:239], v1
    v_add_f32_dpp v48, v78, v79 quad_perm:[0,1,2,3] row_mask:0x2 bank_mask:0xf
    v_smfmac_f32_16x16x64_bf16 v[88:91], v[36:39], a[176:183], v1
    v_add_f32_dpp v49, v110, v111 quad_perm:[0,1,2,3] row_mask:0x2 bank_mask:0xf
    v_smfmac_f32_16x16x64_bf16 v[120:123], v[36:39], a[240:247], v1
    v_add_f32_dpp v46, v80, v81 quad_perm:[0,1,2,3] row_mask:0x4 bank_mask:0xf
    v_smfmac_f32_16x16x64_bf16 v[92:95], v[36:39], a[184:191], v1
    v_add_f32_dpp v47, v112, v113 quad_perm:[0,1,2,3] row_mask:0x4 bank_mask:0xf
    v_smfmac_f32_16x16x64_bf16 v[124:127], v[36:39], a[248:255], v1
    v_add_f32_dpp v48, v86, v87 quad_perm:[0,1,2,3] row_mask:0x4 bank_mask:0xf
    v_add_f32_dpp v49, v118, v119 quad_perm:[0,1,2,3] row_mask:0x4 bank_mask:0xf
    v_add_f32 v40, v40, v41
    v_add_f32_dpp v46, v88, v89 quad_perm:[0,1,2,3] row_mask:0x8 bank_mask:0xf
    v_dot2_f32_bf16 v44, v36, v36, 0
    v_add_f32_dpp v47, v120, v121 quad_perm:[0,1,2,3] row_mask:0x8 bank_mask:0xf
    v_fmac_f32_e64 v46, v40, v2
    v_add_f32_dpp v48, v94, v95 quad_perm:[0,1,2,3] row_mask:0x8 bank_mask:0xf
    v_fmac_f32_e64 v47, v40, v3
    v_add_f32_dpp v49, v126, v127 quad_perm:[0,1,2,3] row_mask:0x8 bank_mask:0xf
    v_pk_add_f32 v[46:47], v[46:47], v[48:49]
    v_dot2_f32_bf16 v44, v37, v37, v44
    v_dot2_f32_bf16 v44, v38, v38, v44
    v_permlane32_swap_b32 v46, v47
    v_add_f32 v48, v46, v47
    v_add_f32_e64 v49, v46, v47
    v_dot2_f32_bf16 v44, v39, v39, v44
    v_cmp_u_f32 vcc, v40, v40
    v_permlane16_swap_b32 v48, v49
    v_add_f32_e64 v48, v48, v49
    v_cvt_pk_bf16_f32 v48, v48, v48
    ds_write_b16 v10, v48
    s_cbranch_vccnz L_nan_D
L_cont_D:
    v_add_f32_dpp v44, v44, v44 row_ror:8 row_mask:0xf bank_mask:0xf
    v_mov_b64 v[96:97], 0
    v_mov_b64_e64 v[100:101], 0
    v_add_f32_dpp v44, v44, v44 row_ror:4 row_mask:0xf bank_mask:0xf
    v_mov_b64 v[104:105], 0
    v_mov_b64 v[108:109], 0
    v_add_f32_dpp v44, v44, v44 row_ror:2 row_mask:0xf bank_mask:0xf
    v_mov_b64 v[112:113], 0
    v_mov_b64 v[116:117], 0
    v_add_f32_dpp v44, v44, v44 row_ror:1 row_mask:0xf bank_mask:0xf
    s_cmp_eq_u32 s7, 0
    s_waitcnt lgkmcnt(0)
    s_barrier
    s_cbranch_scc1 L_ret
L_QK:
    ds_read_b128 v[52:55], v11
    ds_read_b128 v[56:59], v11 offset:128
    v_permlane32_swap_b32 v40, v44
    v_add_f32 v41, v40, v44
    v_add_f32_e64 v40, v40, v44
    s_mov_b32 s78, 0x3ba7c5ac
    s_cmp_eq_u32 s7, 0
    s_waitcnt lgkmcnt(0)
    v_smfmac_f32_16x16x64_bf16 v[96:99], v[52:55], a[0:7], v1
    v_mov_b64_e64 v[120:121], 0
    v_smfmac_f32_16x16x64_bf16 v[96:99], v[56:59], a[8:15], v1
    v_mov_b64_e64 v[124:125], 0
    v_smfmac_f32_16x16x64_bf16 v[100:103], v[52:55], a[16:23], v1
    v_mov_b64_e64 v[64:65], 0
    v_smfmac_f32_16x16x64_bf16 v[100:103], v[56:59], a[24:31], v1
    v_permlane16_swap_b32_e64 v40, v41
    v_smfmac_f32_16x16x64_bf16 v[104:107], v[52:55], a[32:39], v1
    v_add_f32 v42, v40, v41
    v_add_f32 v40, v40, v41
    v_smfmac_f32_16x16x64_bf16 v[104:107], v[56:59], a[40:47], v1
    v_add_f32_e64 v96, v96, v97
    v_smfmac_f32_16x16x64_bf16 v[108:111], v[52:55], a[48:55], v1
    v_permlane32_swap_b32_e64 v40, v42
    v_smfmac_f32_16x16x64_bf16 v[108:111], v[56:59], a[56:63], v1
    v_add_f32_e64 v100, v100, v101
    v_smfmac_f32_16x16x64_bf16 v[112:115], v[52:55], a[64:71], v1
    v_mul_f32_e64 v40, v40, v40
    v_smfmac_f32_16x16x64_bf16 v[112:115], v[56:59], a[72:79], v1
    v_add_f32_e64 v104, v104, v105
    v_smfmac_f32_16x16x64_bf16 v[116:119], v[52:55], a[80:87], v1
    v_fmac_f32 v42, 0xbb000000, v40
    v_smfmac_f32_16x16x64_bf16 v[116:119], v[56:59], a[88:95], v1
    v_add_f32_e64 v108, v108, v109
    v_smfmac_f32_16x16x64_bf16 v[120:123], v[52:55], a[96:103], v1
    v_add_f32 v42, abs(v42), s78
    v_smfmac_f32_16x16x64_bf16 v[120:123], v[56:59], a[104:111], v1
    v_add_f32_e64 v112, v112, v113
    v_smfmac_f32_16x16x64_bf16 v[124:127], v[52:55], a[112:119], v1
    v_rsq_f32_e64 v42, v42
    v_smfmac_f32_16x16x64_bf16 v[124:127], v[56:59], a[120:127], v1
    v_add_f32_e64 v116, v116, v117
    v_mul_f32 v42, 0x4038aa3b, v42
    v_max3_f32 v44, v96, v100, v104
    v_max3_f32 v44, v44, v108, v112
    v_add_f32_e64 v120, v120, v121
    v_mul_f32_dpp v98, v96, v42 quad_perm:[0,1,2,3] row_mask:0x1 bank_mask:0xf
    v_max3_f32 v44, v44, v116, v120
    v_mul_f32_dpp v114, v112, v42 quad_perm:[0,1,2,3] row_mask:0x1 bank_mask:0xf
    v_add_f32 v124, v124, v125
    v_max_f32 v44, v44, v124
    v_mul_f32_dpp v98, v100, v42 quad_perm:[0,1,2,3] row_mask:0x2 bank_mask:0xf
    v_mul_f32_dpp v114, v116, v42 quad_perm:[0,1,2,3] row_mask:0x2 bank_mask:0xf
    v_max_f32_dpp v44, v44, v44 row_ror:8 row_mask:0xf bank_mask:0xf
    v_mul_f32_dpp v98, v104, v42 quad_perm:[0,1,2,3] row_mask:0x4 bank_mask:0xf
    v_mul_f32_dpp v114, v120, v42 quad_perm:[0,1,2,3] row_mask:0x4 bank_mask:0xf
    v_max_f32_dpp v44, v44, v44 row_ror:4 row_mask:0xf bank_mask:0xf
    v_mul_f32_dpp v98, v108, v42 quad_perm:[0,1,2,3] row_mask:0x8 bank_mask:0xf
    v_mul_f32_dpp v114, v124, v42 quad_perm:[0,1,2,3] row_mask:0x8 bank_mask:0xf
    v_max_f32_dpp v44, v44, v44 row_ror:2 row_mask:0xf bank_mask:0xf
    v_mov_b64 v[68:69], 0
    v_mov_b64 v[72:73], 0
    v_max_f32_dpp v44, v44, v44 row_ror:1 row_mask:0xf bank_mask:0xf
    v_fma_f32 v46, -v44, v42, v98
    v_fma_f32 v47, -v44, v42, v114
    v_exp_f32 v46, v46
    v_exp_f32 v47, v47
    v_mov_b64_e64 v[76:77], 0
    v_mov_b32_dpp v50, v46 row_shl:2 row_mask:0xf bank_mask:0xf
    v_cvt_pk_bf16_f32 v50, v46, v50
    v_mov_b32_dpp v56, v47 row_shl:2 row_mask:0xf bank_mask:0xf
    v_add_f32_e64 v45, v46, v47
    v_mov_b32_dpp v51, v50 row_ror:12 row_mask:0xf bank_mask:0xf
    v_mov_b32_dpp v52, v50 row_ror:8 row_mask:0xf bank_mask:0xf
    v_mov_b32_dpp v53, v50 row_ror:4 row_mask:0xf bank_mask:0xf
    v_cvt_pk_bf16_f32 v56, v47, v56
    s_cbranch_scc1 L_int2
L_PV:
    v_smfmac_f32_16x16x64_bf16 v[64:67], v[50:53], v[128:135], v1
    v_add_f32_dpp v45, v45, v45 row_ror:8 row_mask:0xf bank_mask:0xf
    v_mov_b32_dpp v48, v50 row_ror:8 row_mask:0xf bank_mask:0xf
    v_smfmac_f32_16x16x64_bf16 v[68:71], v[50:53], v[136:143], v1
    v_mov_b32_dpp v49, v50 row_ror:4 row_mask:0xf bank_mask:0xf
    v_mov_b64 v[80:81], 0
    v_smfmac_f32_16x16x64_bf16 v[72:75], v[50:53], v[144:151], v1
    v_add_f32_dpp v45, v45, v45 row_ror:4 row_mask:0xf bank_mask:0xf
    v_mov_b64_e64 v[84:85], 0
    v_smfmac_f32_16x16x64_bf16 v[76:79], v[50:53], v[152:159], v1
    v_mov_b64_e64 v[88:89], 0
    v_mov_b32_dpp v57, v56 row_ror:12 row_mask:0xf bank_mask:0xf
    v_smfmac_f32_16x16x64_bf16 v[80:83], v[48:51], v[160:167], v1
    v_add_f32_dpp v45, v45, v45 row_ror:2 row_mask:0xf bank_mask:0xf
    v_mov_b64_e64 v[92:93], 0
    v_smfmac_f32_16x16x64_bf16 v[84:87], v[48:51], v[168:175], v1
    v_mov_b32_dpp v58, v56 row_ror:8 row_mask:0xf bank_mask:0xf
    v_mov_b32_dpp v59, v56 row_ror:4 row_mask:0xf bank_mask:0xf
    v_smfmac_f32_16x16x64_bf16 v[88:91], v[48:51], v[176:183], v1
    v_add_f32_dpp v45, v45, v45 row_ror:1 row_mask:0xf bank_mask:0xf
    v_smfmac_f32_16x16x64_bf16 v[92:95], v[48:51], v[184:191], v1
    v_mov_b32_dpp v54, v56 row_ror:8 row_mask:0xf bank_mask:0xf
    s_cbranch_scc1 L_int3
L_PV2:
    v_smfmac_f32_16x16x64_bf16 v[64:67], v[56:59], v[192:199], v1
    v_add_f32_dpp v45, v45, v45 row_bcast:15 row_mask:0xa bank_mask:0xf
    v_smfmac_f32_16x16x64_bf16 v[68:71], v[56:59], v[200:207], v1
    v_mov_b32_dpp v55, v56 row_ror:4 row_mask:0xf bank_mask:0xf
    v_mul_f32 v44, v44, v42
    v_smfmac_f32_16x16x64_bf16 v[72:75], v[56:59], v[208:215], v1
    v_add_f32_dpp v45, v45, v45 row_bcast:31 row_mask:0xc bank_mask:0xf
    v_smfmac_f32_16x16x64_bf16 v[76:79], v[56:59], v[216:223], v1
    ds_write_b64 v13, v[44:45]
    v_smfmac_f32_16x16x64_bf16 v[80:83], v[54:57], v[224:231], v1
    v_add_f32_e64 v48, v64, v65
    v_smfmac_f32_16x16x64_bf16 v[84:87], v[54:57], v[232:239], v1
    v_add_f32_e64 v49, v68, v69
    v_smfmac_f32_16x16x64_bf16 v[88:91], v[54:57], v[240:247], v1
    v_add_f32_e64 v50, v72, v73
    v_smfmac_f32_16x16x64_bf16 v[92:95], v[54:57], v[248:255], v1
    v_add_f32 v51, v76, v77
    s_cmp_eq_u32 s3, 0
    v_add_f32_dpp v48, v80, v81 quad_perm:[0,1,2,3] row_mask:0x4 bank_mask:0xf
    s_waitcnt lgkmcnt(0)
    v_add_f32_dpp v49, v84, v85 quad_perm:[0,1,2,3] row_mask:0x4 bank_mask:0xf
    s_barrier
    v_add_f32_dpp v50, v88, v89 quad_perm:[0,1,2,3] row_mask:0x4 bank_mask:0xf
    ds_read2st64_b64 v[36:39], v15 offset0:0 offset1:1
    v_add_f32_dpp v51, v92, v93 quad_perm:[0,1,2,3] row_mask:0x4 bank_mask:0xf
    v_permlane16_swap_b32_e64 v48, v50
    ds_read2st64_b64 v[40:43], v15 offset0:2 offset1:3
    v_permlane16_swap_b32_e64 v49, v51
    ds_write_b64 v12, v[48:49]
    s_cbranch_scc0 L_A_other
    s_waitcnt lgkmcnt(1)
    v_max3_f32 v56, v36, v38, v40
    v_max_f32 v56, v56, v42
    v_sub_f32 v36, v36, v56
    v_sub_f32 v38, v38, v56
    v_sub_f32 v40, v40, v56
    v_sub_f32_e64 v42, v42, v56
    s_waitcnt lgkmcnt(0)
    s_barrier
    ds_read2st64_b64 v[44:47], v14 offset0:0 offset1:2
    ds_read2st64_b64 v[48:51], v14 offset0:4 offset1:6
    v_exp_f32 v36, v36
    v_exp_f32 v38, v38
    v_exp_f32 v40, v40
    v_exp_f32 v42, v42
    v_mul_f32 v57, v36, v37
    v_fmac_f32 v57, v38, v39
    v_fmac_f32 v57, v40, v41
    v_fmac_f32 v57, v42, v43
    v_rcp_f32 v60, v57
    v_log_f32 v57, v57
    s_mov_b64 exec, 1
    v_add_f32 v57, v57, v56
    v_min_u32_e64 v57, v57, v5
    buffer_store_dword v57, v32, s[44:47], s69 offen sc1
    s_mov_b64 exec, -1
    s_waitcnt lgkmcnt(0)
    v_pk_mul_f32 v[58:59], v[44:45], v[36:37] op_sel_hi:[1,0]
    v_pk_fma_f32 v[58:59], v[46:47], v[38:39], v[58:59] op_sel_hi:[1,0,1]
    v_pk_fma_f32 v[58:59], v[48:49], v[40:41], v[58:59] op_sel_hi:[1,0,1]
    v_pk_fma_f32 v[58:59], v[50:51], v[42:43], v[58:59] op_sel_hi:[1,0,1]
    v_pk_mul_f32 v[58:59], v[58:59], v[60:61] op_sel_hi:[1,0]
    v_cvt_pk_bf16_f32 v58, v58, v59
    v_min_u32 v36, v58, v5
    s_nop 0
    v_min_u32_dpp v37, v58, v5 quad_perm:[1,1,1,1] row_mask:0xf bank_mask:0xf
    v_min_u32_dpp v38, v58, v5 quad_perm:[2,2,2,2] row_mask:0xf bank_mask:0xf
    v_min_u32_dpp v39, v58, v5 quad_perm:[3,3,3,3] row_mask:0xf bank_mask:0xf
    s_mov_b64 exec, s[40:41]
    buffer_store_dwordx4 v[36:39], v32, s[44:47], s68 offen sc1
    s_mov_b64 exec, -1
L_A_done:
    s_barrier
    s_cmp_eq_u32 s7, 0
    s_cbranch_scc0 L_hooked_b
    v_mov_b32 v52, -1
    v_mov_b32 v53, -1
    v_mov_b32 v54, -1
    v_mov_b32_e64 v55, -1
    s_and_b32 s78, s4, 3
    s_lshl_b32 s78, s78, 7
    s_add_u32 s78, s78, s81
    s_lshl_b32 s78, s78, 8
    s_andn2_b32 s80, s78, 8191
    s_add_u32 s78, s78, s80
    s_add_u32 s78, s78, s35
    s_add_u32 s78, s78, 147456
    s_cmp_lt_u32 s78, 360448
    s_cselect_b32 s78, s78, s46
    s_mov_b64 exec, s[40:41]
    buffer_store_dwordx4 v[52:55], v16, s[44:47], s78 offen sc1
    s_mov_b64 exec, -1
    s_and_b32 s80, s5, 3
    s_xor_b32 s80, s80, 1
    s_lshl_b32 s80, s80, 10
    s_add_u32 m0, s76, s80
    s_lshl_b32 s80, s80, 5
    buffer_load_dwordx4 v33, s[60:63], s80 offen lds
    s_and_b32 s80, s5, 3
    s_xor_b32 s80, s80, 2
    s_lshl_b32 s80, s80, 10
    s_add_u32 m0, s76, s80
    s_lshl_b32 s80, s80, 5
    buffer_load_dwordx4 v33, s[60:63], s80 offen lds
    s_and_b32 s80, s5, 3
    s_xor_b32 s80, s80, 3
    s_lshl_b32 s80, s80, 10
    s_add_u32 m0, s76, s80
    s_lshl_b32 s80, s80, 5
    buffer_load_dwordx4 v33, s[60:63], s80 offen lds
    s_add_u32 m0, s76, 4096
    s_nop 0
    buffer_load_dwordx4 v34, s[48:51], 0 offen lds
L_hooked_b:
    s_sleep 5
    buffer_load_dwordx2 v[48:49], v18, s[44:47], s39 offen sc1
    buffer_load_dwordx4 v[40:43], v17, s[44:47], s39 offen sc1
    buffer_load_dwordx4 v[44:47], v17, s[44:47], s39 offen offset:256 sc1
    v_mov_b64 v[58:59], 0
    v_mov_b64 v[60:61], 0
    s_cmp_eq_u32 s7, 0
    s_cbranch_scc1 L_wait_A0
    ds_read_b64_tr_b16 v[64:65], v35 offset:0
    ds_read_b64_tr_b16 v[66:67], v35 offset:512
    ds_read_b64_tr_b16 v[68:69], v35 offset:1024
    ds_read_b64_tr_b16 v[70:71], v35 offset:1536
    ds_read_b64_tr_b16 v[72:73], v35 offset:2048
    ds_read_b64_tr_b16 v[74:75], v35 offset:2560
    ds_read_b64_tr_b16 v[76:77], v35 offset:3072
    ds_read_b64_tr_b16 v[78:79], v35 offset:3584
    buffer_load_dwordx2 v[6:7], v9, s[44:47], s34 offen sc1
    s_waitcnt vmcnt(3) lgkmcnt(0)
    v_sub_f32 v51, v49, v48
    v_exp_f32 v51, v51
    s_cmp_eq_u32 s3, 0
    v_add_f32_e64 v51, 1.0, v51
    v_rcp_f32 v51, v51
    s_waitcnt vmcnt(2)
    v_smfmac_f32_16x16x64_bf16 v[58:61], v[40:43], v[64:71], v1
    s_waitcnt vmcnt(1)
    v_smfmac_f32_16x16x64_bf16 v[58:61], v[44:47], v[72:79], v1
    s_nop 7
L_S3:
    v_pk_add_f32 v[52:53], v[58:59], v[60:61] neg_lo:[0,1] neg_hi:[0,1]
    v_pk_fma_f32 v[52:53], v[52:53], v[50:51], v[60:61] op_sel:[0,1,0]
    v_add_f32_e64 v53, v52, v53
    ds_write_b32 v19, v53
    v_cmp_u_f32_e64 vcc, v53, v53
    s_cbranch_vccnz L_nan_A
L_cont_A:
    s_waitcnt lgkmcnt(0)
    s_barrier
    s_cbranch_scc0 L_Y_done
    ds_read2st64_b32 v[36:37], v20 offset0:0 offset1:1
    ds_read2st64_b32 v[38:39], v20 offset0:2 offset1:3
    s_xor_b32 s78, s39, 8192
    s_waitcnt lgkmcnt(0)
    v_pk_add_f32 v[36:37], v[36:37], v[38:39]
    v_add_f32 v36, v36, v37
    s_nop 0
    s_nop 0
    v_mov_b32_dpp v41, v36 row_shl:1 row_mask:0xf bank_mask:0xf
    v_cvt_pk_bf16_f32 v36, v36, v41
    v_min_u32 v40, v36, v5
    s_nop 0
    v_min_u32_dpp v41, v36, v5 row_shl:2 row_mask:0xf bank_mask:0xf
    v_min_u32_dpp v42, v36, v5 row_shl:4 row_mask:0xf bank_mask:0xf
    v_min_u32_dpp v43, v36, v5 row_shl:6 row_mask:0xf bank_mask:0xf
    s_mov_b64 exec, s[32:33]
    buffer_store_dwordx4 v[40:43], v21, s[44:47], s78 offen sc1
    buffer_store_dwordx4 v[40:43], v21, s[44:47], s39 offen sc1
    s_mov_b64 exec, -1
L_Y_done:
    s_cmp_eq_u32 s6, 2
    s_barrier
    s_cbranch_scc1 L_G
    s_cmp_eq_u32 s7, 0
    s_cbranch_scc0 L_sw1
    s_add_u32 m0, s76, 8192
    s_nop 0
    buffer_load_dwordx4 v34, s[52:55], s58 offen lds
    s_add_u32 m0, s76, 9216
    s_add_u32 s80, s57, s58
    buffer_load_dwordx4 v34, s[52:55], s80 offen lds
    s_add_u32 m0, s76, 10240
    s_add_u32 s80, s56, s58
    buffer_load_dwordx4 v34, s[52:55], s80 offen lds
    s_add_u32 m0, s76, 11264
    s_add_u32 s80, s56, s57
    s_add_u32 s80, s80, s58
    buffer_load_dwordx4 v34, s[52:55], s80 offen lds
L_sw1:
    s_sleep 10
    s_add_u32 s78, s39, 16384
    buffer_load_dwordx4 v[64:67], v22, s[44:47], s39 offen offset:0 sc1
    buffer_load_dwordx4 v[68:71], v22, s[44:47], s78 offen offset:0 sc1
    buffer_load_dwordx4 v[72:75], v22, s[44:47], s39 offen offset:256 sc1
    buffer_load_dwordx4 v[76:79], v22, s[44:47], s78 offen offset:256 sc1
    v_and_b32 v36, 15, v0
    v_and_b32 v37, 1, v0
    v_lshlrev_b32 v37, 4, v37
    v_mov_b32 v38, 0x3f80
    v_lshlrev_b32 v37, v37, v38
    v_lshrrev_b32 v36, 1, v36
    v_cmp_eq_u32 vcc, 0, v36
    v_mov_b32 v44, v28
    s_nop 0
    v_cndmask_b32 v112, 0, v37, vcc
    v_cmp_eq_u32 vcc, 1, v36
    v_mov_b32 v45, v28
    s_nop 0
    v_cndmask_b32 v113, 0, v37, vcc
    v_cmp_eq_u32 vcc, 2, v36
    v_mov_b32 v46, v28
    s_nop 0
    v_cndmask_b32 v114, 0, v37, vcc
    v_cmp_eq_u32 vcc, 3, v36
    v_mov_b32 v47, v28
    s_nop 0
    v_cndmask_b32 v115, 0, v37, vcc
    v_cmp_eq_u32 vcc, 4, v36
    v_mov_b32 v48, v28
    s_nop 0
    v_cndmask_b32 v116, 0, v37, vcc
    v_cmp_eq_u32 vcc, 5, v36
    v_mov_b32 v49, v28
    s_nop 0
    v_cndmask_b32 v117, 0, v37, vcc
    v_cmp_eq_u32 vcc, 6, v36
    v_mov_b32 v50, v28
    s_nop 0
    v_cndmask_b32 v118, 0, v37, vcc
    v_cmp_eq_u32 vcc, 7, v36
    v_mov_b32 v51, v28
    s_nop 0
    v_cndmask_b32 v119, 0, v37, vcc
    v_mov_b64 v[52:53], 0
    v_mov_b64 v[54:55], 0
    v_mov_b64 v[56:57], 0
    v_mov_b64 v[58:59], 0
    s_cmp_ge_u32 s4, 3
    s_addc_u32 s80, s4, 0
    s_and_b32 s37, s80, 3
    s_lshl_b32 s37, s37, 7
    s_and_b32 s80, s80, 4
    s_lshl_b32 s80, s80, 12
    s_add_u32 s37, s37, s80
    s_add_u32 s37, s37, s7
    s_add_u32 s37, s37, 153088
    s_waitcnt vmcnt(4)
    ds_read_b64_tr_b16 v[80:81], v35 offset:4096
    ds_read_b64_tr_b16 v[82:83], v35 offset:4608
    ds_read_b64_tr_b16 v[84:85], v35 offset:5120
    ds_read_b64_tr_b16 v[86:87], v35 offset:5632
    ds_read_b64_tr_b16 v[88:89], v35 offset:6144
    ds_read_b64_tr_b16 v[90:91], v35 offset:6656
    ds_read_b64_tr_b16 v[92:93], v35 offset:7168
    ds_read_b64_tr_b16 v[94:95], v35 offset:7680
    ds_read_b64_tr_b16 v[96:97], v35 offset:8192
    ds_read_b64_tr_b16 v[98:99], v35 offset:8704
    ds_read_b64_tr_b16 v[100:101], v35 offset:9216
    ds_read_b64_tr_b16 v[102:103], v35 offset:9728
    ds_read_b64_tr_b16 v[104:105], v35 offset:10240
    ds_read_b64_tr_b16 v[106:107], v35 offset:10752
    ds_read_b64_tr_b16 v[108:109], v35 offset:11264
    ds_read_b64_tr_b16 v[110:111], v35 offset:11776
    v_max_u32 v36, v6, v7
    v_cmp_lt_u32 vcc, s59, v36
    s_cbranch_vccnz L_retry_E
L_cont_E:
    v_lshlrev_b32_e64 v120, 16, v6
    v_and_b32 v121, 0xffff0000, v6
    v_lshlrev_b32_e64 v122, 16, v7
    v_and_b32 v123, 0xffff0000, v7
    s_nop 0
L_wait_B:
    s_waitcnt vmcnt(3)
    v_mfma_f32_16x16x32_bf16 v[124:127], v[112:115], v[64:67], v[120:123]
    s_waitcnt vmcnt(2)
    v_mfma_f32_16x16x32_bf16 v[124:127], v[112:115], v[68:71], v[124:127]
    s_waitcnt vmcnt(1)
    v_mfma_f32_16x16x32_bf16 v[124:127], v[116:119], v[72:75], v[124:127]
    s_waitcnt vmcnt(0)
    v_mfma_f32_16x16x32_bf16 v[124:127], v[116:119], v[76:79], v[124:127]
    s_cmp_eq_u32 s3, 0
    s_waitcnt lgkmcnt(0)
    s_nop 5
    v_cvt_pk_bf16_f32 v36, v124, v125
    v_cvt_pk_bf16_f32 v37, v126, v127
    v_dot2_f32_bf16 v40, v36, v28, 0
    v_dot2_f32_bf16 v41, v36, v36, 0
    v_dot2_f32_bf16 v40, v37, v28, v40
    v_dot2_f32_bf16 v41, v37, v37, v41
    v_mov_b32_dpp v44, v36 quad_perm:[0,1,2,3] row_mask:0xf bank_mask:0x1
    v_mov_b32_dpp v45, v37 quad_perm:[0,1,2,3] row_mask:0xf bank_mask:0x1
    v_mov_b32_dpp v46, v36 row_shl:4 row_mask:0xf bank_mask:0x1
    v_mov_b32_dpp v47, v37 row_shl:4 row_mask:0xf bank_mask:0x1
    v_mov_b32_dpp v48, v36 row_shl:8 row_mask:0xf bank_mask:0x1
    v_mov_b32_dpp v49, v37 row_shl:8 row_mask:0xf bank_mask:0x1
    v_smfmac_f32_16x16x64_bf16 v[52:55], v[44:47], v[80:87], v1
    v_mov_b32_dpp v50, v36 row_shl:12 row_mask:0xf bank_mask:0x1
    v_mov_b32_dpp v51, v37 row_shl:12 row_mask:0xf bank_mask:0x1
    v_smfmac_f32_16x16x64_bf16 v[56:59], v[44:47], v[96:103], v1
    v_add_f32_dpp v40, v40, v40 quad_perm:[1,0,3,2] row_mask:0xf bank_mask:0xf
    v_smfmac_f32_16x16x64_bf16 v[52:55], v[48:51], v[88:95], v1
    v_add_f32_dpp v41, v41, v41 quad_perm:[1,0,3,2] row_mask:0xf bank_mask:0xf
    v_smfmac_f32_16x16x64_bf16 v[56:59], v[48:51], v[104:111], v1
    v_add_f32_dpp v40, v40, v40 row_ror:4 row_mask:0xf bank_mask:0xf
    v_add_f32_dpp v41, v41, v41 row_ror:4 row_mask:0xf bank_mask:0xf
    s_nop 0
    v_add_f32_dpp v40, v40, v40 row_ror:8 row_mask:0xf bank_mask:0xf
    v_add_f32_dpp v41, v41, v41 row_ror:8 row_mask:0xf bank_mask:0xf
    s_nop 0
    v_add_f32 v60, v52, v53
    v_add_f32 v36, v54, v55
    v_permlane32_swap_b32 v40, v41
    v_add_f32 v61, v56, v57
    v_add_f32 v37, v58, v59
    v_add_f32 v42, v40, v41
    v_add_f32 v40, v40, v41
    v_permlane32_swap_b32 v60, v36
    v_permlane32_swap_b32 v61, v37
    v_permlane16_swap_b32 v40, v42
    ds_write_b64 v23, v[60:61]
    v_add_f32_e64 v40, v40, v42
    ds_write_b32 v24, v40
    v_cmp_u_f32_e64 vcc, v40, v40
    s_cbranch_vccnz L_nan_B
L_cont_B:
    s_waitcnt lgkmcnt(0)
    s_barrier
    s_cbranch_scc0 L_H_other
    ds_read_b128 v[36:39], v26
    ds_read_b128 v[40:43], v26 offset:16
    ds_read2_b64 v[64:67], v25 offset0:0 offset1:16
    ds_read2_b64 v[68:71], v25 offset0:64 offset1:80
    ds_read2_b64 v[72:75], v25 offset0:128 offset1:144
    ds_read2_b64 v[76:79], v25 offset0:192 offset1:208
    v_mov_b32 v54, 0xc0135761
    s_mov_b32 s78, 0x3ba7c5ac
    s_waitcnt lgkmcnt(4)
    v_pk_add_f32 v[36:37], v[36:37], v[38:39]
    v_pk_add_f32 v[40:41], v[40:41], v[42:43]
    v_pk_add_f32 v[36:37], v[36:37], v[40:41]
    v_mul_f32 v38, 0xbb000000, v36
    v_fmac_f32 v37, v38, v36
    v_add_f32 v36, abs(v37), s78
    v_rsq_f32 v36, v36
    s_waitcnt lgkmcnt(0)
    v_pk_add_f32 v[64:65], v[64:65], v[68:69]
    v_pk_add_f32 v[72:73], v[72:73], v[76:77]
    v_pk_add_f32 v[66:67], v[66:67], v[70:71]
    v_pk_add_f32 v[74:75], v[74:75], v[78:79]
    v_mul_f32 v36, 0x41b504f3, v36
    v_pk_add_f32 v[64:65], v[64:65], v[72:73]
    v_pk_add_f32 v[66:67], v[66:67], v[74:75]
    v_pk_fma_f32 v[64:65], v[66:67], v[38:39], v[64:65] op_sel_hi:[1,0,1]
    v_pk_mul_f32 v[64:65], v[64:65], v[36:37] op_sel_hi:[1,0]
    v_mul_f32_e64 v46, v64, v64
    v_fmac_f32 v54, 0xbdd2d3e8, v46
    v_mul_f32 v54, v54, v64
    v_exp_f32 v54, v54
    v_mul_f32 v64, v64, v65
    v_add_f32 v54, 1.0, v54
    v_rcp_f32 v54, v54
    s_nop 0
    v_mul_f32 v64, v64, v54
    s_nop 1
    v_mov_b32_dpp v49, v64 row_shl:1 row_mask:0xf bank_mask:0xf
    v_cvt_pk_bf16_f32 v64, v64, v49
    v_min_u32 v48, v64, v5
    s_nop 0
    v_min_u32_dpp v49, v64, v5 row_shl:2 row_mask:0xf bank_mask:0xf
    v_min_u32_dpp v50, v64, v5 row_shl:4 row_mask:0xf bank_mask:0xf
    v_min_u32_dpp v51, v64, v5 row_shl:6 row_mask:0xf bank_mask:0xf
    s_mov_b64 exec, s[32:33]
    buffer_store_dwordx4 v[48:51], v27, s[44:47], s7 offen sc1
    s_mov_b64 exec, -1
L_H_done:
    s_cmp_eq_u32 s7, 0
    s_cbranch_scc0 L_end
    s_cmp_eq_u32 s3, 0
    s_cbranch_scc0 L_nohint2
    s_add_u32 s37, s39, 153088
    v_and_b32 v37, 3, v0
    v_lshlrev_b32 v37, 7, v37
    v_and_b32_e64 v36, 4, v0
    v_lshl_add_u32 v37, v36, 12, v37
    s_mov_b64 exec, 128
L_hp2:
    buffer_load_dword v36, v37, s[44:47], s37 offen sc1
    s_add_u32 s38, s38, 1
    s_cmp_gt_u32 s38, 400000
    s_cbranch_scc1 L_end
    s_waitcnt vmcnt(0)
    v_cmp_eq_u32 vcc, -1, v36
    s_cbranch_vccnz L_hp2
    s_mov_b64 exec, -1
    s_cmp_ge_u32 s4, 4
    s_cbranch_scc0 L_nohint2
    s_sleep 2
L_nohint2:
    s_branch L_D
L_G:
    s_cmp_eq_u32 s7, 0
    s_cbranch_scc0 L_sw2
    s_add_u32 m0, s76, 8192
    s_nop 0
    buffer_load_dwordx4 v34, s[52:55], s58 offen lds
    s_add_u32 m0, s76, 9216
    s_add_u32 s80, s57, s58
    buffer_load_dwordx4 v34, s[52:55], s80 offen lds
    s_add_u32 m0, s76, 10240
    s_add_u32 s80, s56, s58
    buffer_load_dwordx4 v34, s[52:55], s80 offen lds
    s_add_u32 m0, s76, 11264
    s_add_u32 s80, s56, s57
    s_add_u32 s80, s80, s58
    buffer_load_dwordx4 v34, s[52:55], s80 offen lds
    s_cmp_eq_u32 s6, 2
    s_cbranch_scc0 L_sw2
    s_add_u32 m0, s76, 12288
    s_add_u32 s80, s58, s58
    buffer_load_dwordx4 v34, s[52:55], s80 offen lds
    s_add_u32 m0, s76, 13312
    s_add_u32 s80, s57, s58
    s_add_u32 s80, s80, s58
    buffer_load_dwordx4 v34, s[52:55], s80 offen lds
    s_add_u32 m0, s76, 14336
    s_add_u32 s80, s56, s58
    s_add_u32 s80, s80, s58
    buffer_load_dwordx4 v34, s[52:55], s80 offen lds
    s_add_u32 m0, s76, 15360
    s_add_u32 s80, s56, s57
    s_add_u32 s80, s80, s58
    s_add_u32 s80, s80, s58
    buffer_load_dwordx4 v34, s[52:55], s80 offen lds
L_sw2:
    s_cmp_eq_u32 s3, 0
    s_cbranch_scc0 L_G_res_done
    s_sleep 14
L_poll_R:
    s_add_u32 s78, s39, 0
    buffer_load_dword v36, v26, s[44:47], s78 offen offset:0 sc1
    buffer_load_dword v37, v26, s[44:47], s78 offen offset:2048 sc1
    s_add_u32 s78, s39, 4096
    buffer_load_dword v38, v26, s[44:47], s78 offen offset:0 sc1
    buffer_load_dword v39, v26, s[44:47], s78 offen offset:2048 sc1
    s_add_u32 s78, s39, 16384
    buffer_load_dword v40, v26, s[44:47], s78 offen offset:0 sc1
    buffer_load_dword v41, v26, s[44:47], s78 offen offset:2048 sc1
    s_add_u32 s78, s39, 20480
    buffer_load_dword v42, v26, s[44:47], s78 offen offset:0 sc1
    buffer_load_dword v43, v26, s[44:47], s78 offen offset:2048 sc1
    s_waitcnt vmcnt(0)
    v_max3_u32 v44, v36, v37, v38
    v_max3_u32 v44, v44, v39, v40
    v_max3_u32 v44, v44, v41, v42
    v_max_u32 v44, v44, v43
    v_cmp_eq_u32 vcc, -1, v44
    s_cbranch_vccnz L_retry_R
    s_mov_b64 exec, -1
    v_dot2_f32_bf16 v4, v36, v27, v4
    v_dot2_f32_bf16 v4, v37, v27, v4
    v_dot2_f32_bf16 v4, v38, v27, v4
    v_dot2_f32_bf16 v4, v39, v27, v4
    v_dot2_f32_bf16 v4, v40, v27, v4
    v_dot2_f32_bf16 v4, v41, v27, v4
    v_dot2_f32_bf16 v4, v42, v27, v4
    v_dot2_f32_bf16 v4, v43, v27, v4
    s_nop 0
    s_nop 1
    v_cvt_pk_bf16_f32 v4, v4, v4
    v_lshlrev_b32 v4, 16, v4
L_G_res_done:
    v_mov_b64 v[64:65], 0
    v_mov_b64 v[66:67], 0
    v_mov_b64 v[68:69], 0
    v_mov_b64 v[70:71], 0
    v_mov_b64 v[36:37], 0
    v_mov_b64 v[38:39], 0
    v_mov_b64 v[40:41], 0
    v_mov_b64 v[42:43], 0
    v_mov_b64 v[44:45], 0
    v_mov_b64 v[46:47], 0
    v_mov_b64 v[48:49], 0
    s_add_u32 s77, s7, 153472
    s_cmp_eq_u32 s36, 27
    s_cselect_b32 s77, s77, 0x1000000
    s_cmp_eq_u32 s3, 3
    s_mov_b32 s42, 0x0fff0fff
    s_mov_b32 s43, s42
    s_cselect_b32 s82, 0xff, s42
    s_cselect_b32 s83, 0, s42
    s_cmp_eq_u32 s3, 0
    s_cbranch_scc0 L_G_go
    s_add_u32 s37, s39, 153088
    v_and_b32 v53, 3, v0
    v_lshlrev_b32 v53, 7, v53
    v_and_b32_e64 v52, 4, v0
    v_lshl_add_u32 v53, v52, 12, v53
    s_cmp_eq_u32 s7, 0
    s_movk_i32 exec_lo, 96
    s_cselect_b32 exec_lo, 119, exec_lo
    s_mov_b32 exec_hi, 0
L_hp1:
    buffer_load_dword v52, v53, s[44:47], s37 offen sc1
    s_add_u32 s38, s38, 1
    s_cmp_gt_u32 s38, 400000
    s_cbranch_scc1 L_end
    s_waitcnt vmcnt(0)
    v_cmp_eq_u32 vcc, -1, v52
    s_cbranch_vccnz L_hp1
    s_mov_b64 exec, -1
    s_sleep 1
    s_cmp_eq_u32 s7, 0
    s_cbranch_scc0 L_G_go
    s_sleep 1
L_G_go:
    s_waitcnt vmcnt(0)
    s_barrier
    s_mov_b64 exec, s[42:43]
    buffer_load_dwordx4 v[64:67], v22, s[44:47], s39 offen sc1
    s_mov_b64 exec, s[82:83]
    buffer_load_dwordx4 v[68:71], v22, s[44:47], s39 offen offset:768 sc1
    s_mov_b64 exec, -1
    ds_read_b64_tr_b16 v[80:81], v35 offset:4096
    ds_read_b64_tr_b16 v[82:83], v35 offset:4608
    ds_read_b64_tr_b16 v[84:85], v35 offset:5120
    ds_read_b64_tr_b16 v[86:87], v35 offset:5632
    ds_read_b64_tr_b16 v[88:89], v35 offset:6144
    ds_read_b64_tr_b16 v[90:91], v35 offset:6656
    ds_read_b64_tr_b16 v[92:93], v35 offset:7168
    ds_read_b64_tr_b16 v[94:95], v35 offset:7680
    ds_read_b64_tr_b16 v[96:97], v35 offset:8192
    ds_read_b64_tr_b16 v[98:99], v35 offset:8704
    ds_read_b64_tr_b16 v[100:101], v35 offset:9216
    ds_read_b64_tr_b16 v[102:103], v35 offset:9728
    ds_read_b64_tr_b16 v[104:105], v35 offset:10240
    ds_read_b64_tr_b16 v[106:107], v35 offset:10752
    ds_read_b64_tr_b16 v[108:109], v35 offset:11264
    ds_read_b64_tr_b16 v[110:111], v35 offset:11776
    s_mov_b64 exec, 12
    buffer_store_dword v5, v32, s[44:47], s77 offen sc1
    s_mov_b64 exec, -1
    ds_read_b64_tr_b16 v[112:113], v35 offset:12288
    ds_read_b64_tr_b16 v[114:115], v35 offset:12800
    ds_read_b64_tr_b16 v[116:117], v35 offset:13312
    ds_read_b64_tr_b16 v[118:119], v35 offset:13824
    ds_read_b64_tr_b16 v[120:121], v35 offset:14336
    ds_read_b64_tr_b16 v[122:123], v35 offset:14848
    ds_read_b64_tr_b16 v[124:125], v35 offset:15360
    ds_read_b64_tr_b16 v[126:127], v35 offset:15872
    s_waitcnt vmcnt(2) lgkmcnt(0)
L_got_C:
    v_smfmac_f32_16x16x64_bf16 v[36:39], v[64:67], v[80:87], v1
    v_smfmac_f32_16x16x64_bf16 v[40:43], v[64:67], v[96:103], v1
    v_smfmac_f32_16x16x64_bf16 v[44:47], v[64:67], v[112:119], v1
    s_waitcnt vmcnt(1)
    v_smfmac_f32_16x16x64_bf16 v[36:39], v[68:71], v[88:95], v1
    s_nop 0
    s_nop 0
    v_smfmac_f32_16x16x64_bf16 v[40:43], v[68:71], v[104:111], v1
    s_nop 0
    s_cmp_eq_u32 s3, 0
    v_smfmac_f32_16x16x64_bf16 v[44:47], v[68:71], v[120:127], v1
    s_nop 0
    s_nop 0
    v_add_f32_dpp v48, v36, v37 quad_perm:[0,1,2,3] row_mask:0x1 bank_mask:0xf
    v_add_f32_dpp v49, v38, v39 quad_perm:[0,1,2,3] row_mask:0x1 bank_mask:0xf
    s_nop 0
    v_add_f32_dpp v48, v40, v41 quad_perm:[0,1,2,3] row_mask:0x2 bank_mask:0xf
    v_add_f32_dpp v49, v42, v43 quad_perm:[0,1,2,3] row_mask:0x2 bank_mask:0xf
    s_nop 0
    v_add_f32_dpp v48, v44, v45 quad_perm:[0,1,2,3] row_mask:0x4 bank_mask:0xf
    v_add_f32_dpp v49, v46, v47 quad_perm:[0,1,2,3] row_mask:0x4 bank_mask:0xf
    s_nop 1
    v_permlane32_swap_b32 v48, v49
    v_add_f32_e64 v50, v48, v49
    ds_write_b32 v23, v50
    v_cmp_u_f32_e64 vcc, v50, v50
    s_cbranch_vccnz L_nan_C
L_cont_C:
    s_waitcnt lgkmcnt(0)
    s_barrier
    s_cbranch_scc0 L_X_done
    ds_read2_b32 v[36:37], v24 offset0:0 offset1:32
    ds_read2_b32 v[38:39], v24 offset0:64 offset1:96
    ds_read2_b32 v[40:41], v24 offset0:128 offset1:160
    ds_read2_b32 v[42:43], v24 offset0:192 offset1:224
    s_cmp_eq_u32 s7, 0
    s_waitcnt lgkmcnt(2)
    v_pk_add_f32 v[36:37], v[36:37], v[38:39]
    v_add_f32 v36, v36, v4
    s_waitcnt lgkmcnt(0)
    v_pk_add_f32 v[40:41], v[40:41], v[42:43]
    v_pk_add_f32 v[36:37], v[36:37], v[40:41]
    v_add_f32 v36, v36, v37
    s_nop 1
    v_mov_b32_dpp v41, v36 row_shl:1 row_mask:0xf bank_mask:0xf
    v_cvt_pk_bf16_f32 v36, v36, v41
    v_min_u32 v40, v36, v5
    s_nop 0
    v_min_u32_dpp v41, v36, v5 row_shl:2 row_mask:0xf bank_mask:0xf
    v_min_u32_dpp v42, v36, v5 row_shl:4 row_mask:0xf bank_mask:0xf
    v_min_u32_dpp v43, v36, v5 row_shl:6 row_mask:0xf bank_mask:0xf
    s_mov_b64 exec, s[32:33]
    s_cbranch_scc0 L_out
    buffer_store_dwordx4 v[40:43], v25, s[64:67], s70 offen sc1
    s_mov_b64 exec, -1
    v_lshlrev_b32_e64 v4, 16, v36
L_X_done:
    s_cmp_eq_u32 s7, 0
    s_cbranch_scc0 L_end
    s_branch L_D
L_H_other:
    s_cmp_eq_u32 s81, 125
    s_cbranch_scc0 L_H_done
    s_mov_b64 exec, 3
    buffer_store_dword v5, v32, s[44:47], s37 offen sc1
    s_mov_b64 exec, -1
    s_branch L_H_done
L_out:
    buffer_store_dwordx4 v[40:43], v25, s[64:67], s70 offen nt
    s_mov_b64 exec, -1
    s_endpgm
L_A_other:
    s_waitcnt lgkmcnt(0)
    s_barrier
    s_branch L_A_done
L_nan_D:
    v_max3_u32 v50, v36, v37, v38
    v_max_u32 v50, v50, v39
    v_cmp_lt_u32 vcc, s59, v50
    s_cbranch_vccz L_cont_D
    v_mov_b64 v[64:65], 0
    v_mov_b64 v[70:71], 0
    v_mov_b64 v[72:73], 0
    v_mov_b64 v[78:79], 0
    v_mov_b64 v[80:81], 0
    v_mov_b64 v[86:87], 0
    v_mov_b64 v[88:89], 0
    v_mov_b64 v[94:95], 0
    v_mov_b64 v[96:97], 0
    v_mov_b64 v[102:103], 0
    v_mov_b64 v[104:105], 0
    v_mov_b64 v[110:111], 0
    v_mov_b64 v[112:113], 0
    v_mov_b64 v[118:119], 0
    v_mov_b64 v[120:121], 0
    v_mov_b64 v[126:127], 0
L_retry_D:
    s_mov_b64 exec, vcc
    buffer_load_dwordx4 v[36:39], v8, s[44:47], s79 offen sc1
    s_add_u32 s99, s99, 1
    s_cmp_gt_u32 s99, 400000
    s_cbranch_scc1 L_end
    s_waitcnt vmcnt(0)
    v_max3_u32 v50, v36, v37, v38
    v_max_u32 v50, v50, v39
    v_cmp_eq_u32 vcc, -1, v50
    s_cbranch_vccnz L_retry_D
    s_mov_b64 exec, -1
    s_branch L_S1
L_retry_E:
    s_mov_b64 exec, vcc
    buffer_load_dwordx2 v[6:7], v9, s[44:47], s34 offen sc1
    s_add_u32 s99, s99, 1
    s_cmp_gt_u32 s99, 400000
    s_cbranch_scc1 L_end
    s_waitcnt vmcnt(0)
    v_max_u32 v36, v6, v7
    v_cmp_eq_u32 vcc, -1, v36
    s_cbranch_vccnz L_retry_E
    s_mov_b64 exec, -1
    s_branch L_cont_E
L_nan_A:
    v_max3_u32 v50, v40, v41, v42
    v_max3_u32 v50, v50, v43, v44
    v_max3_u32 v50, v50, v45, v46
    v_max3_u32 v50, v50, v47, v48
    v_max_u32 v50, v50, v49
    v_cmp_eq_u32 vcc, -1, v50
    s_cbranch_vccz L_cont_A
    v_mov_b64 v[58:59], 0
    v_mov_b64 v[60:61], 0
L_retry_A:
    s_mov_b64 exec, vcc
    buffer_load_dwordx2 v[48:49], v18, s[44:47], s39 offen sc1
    buffer_load_dwordx4 v[40:43], v17, s[44:47], s39 offen sc1
    buffer_load_dwordx4 v[44:47], v17, s[44:47], s39 offen offset:256 sc1
    s_add_u32 s96, s96, 1
    s_cmp_gt_u32 s96, 400000
    s_cbranch_scc1 L_end
    s_waitcnt vmcnt(0)
    v_max3_u32 v50, v40, v41, v42
    v_max3_u32 v50, v50, v43, v44
    v_max3_u32 v50, v50, v45, v46
    v_max3_u32 v50, v50, v47, v48
    v_max_u32 v50, v50, v49
    v_cmp_eq_u32 vcc, -1, v50
    s_cbranch_vccnz L_retry_A
    s_mov_b64 exec, -1
    s_branch L_got_A
L_wait_A0:
    s_barrier
    s_cmp_eq_u32 s6, 2
    s_cbranch_scc1 L_wait_A0G
    s_add_u32 m0, s76, 5120
    s_nop 0
    buffer_load_dwordx4 v34, s[48:51], s57 offen lds
    s_add_u32 m0, s76, 6144
    s_nop 0
    buffer_load_dwordx4 v34, s[48:51], s56 offen lds
    s_add_u32 m0, s76, 7168
    s_add_u32 s80, s56, s57
    buffer_load_dwordx4 v34, s[48:51], s80 offen lds
    s_waitcnt vmcnt(7)
    ds_read_b64_tr_b16 v[64:65], v35 offset:0
    ds_read_b64_tr_b16 v[66:67], v35 offset:512
    ds_read_b64_tr_b16 v[68:69], v35 offset:1024
    ds_read_b64_tr_b16 v[70:71], v35 offset:1536
    ds_read_b64_tr_b16 v[72:73], v35 offset:2048
    ds_read_b64_tr_b16 v[74:75], v35 offset:2560
    ds_read_b64_tr_b16 v[76:77], v35 offset:3072
    ds_read_b64_tr_b16 v[78:79], v35 offset:3584
    s_waitcnt vmcnt(3) lgkmcnt(0)
L_got_A:
    v_smfmac_f32_16x16x64_bf16 v[58:61], v[40:43], v[64:71], v1
    v_smfmac_f32_16x16x64_bf16 v[58:61], v[44:47], v[72:79], v1
    v_sub_f32 v51, v49, v48
    v_exp_f32 v51, v51
    s_cmp_eq_u32 s3, 0
    v_add_f32 v51, 1.0, v51
    v_rcp_f32 v51, v51
    s_nop 1
    s_branch L_S3
L_wait_A0G:
    s_add_u32 m0, s76, 5120
    s_nop 0
    buffer_load_dwordx4 v34, s[48:51], s57 offen lds
    s_add_u32 m0, s76, 6144
    s_nop 0
    buffer_load_dwordx4 v34, s[48:51], s56 offen lds
    s_add_u32 m0, s76, 7168
    s_add_u32 s80, s56, s57
    buffer_load_dwordx4 v34, s[48:51], s80 offen lds
    s_waitcnt vmcnt(7)
    ds_read_b64_tr_b16 v[64:65], v35 offset:0
    ds_read_b64_tr_b16 v[66:67], v35 offset:512
    ds_read_b64_tr_b16 v[68:69], v35 offset:1024
    ds_read_b64_tr_b16 v[70:71], v35 offset:1536
    ds_read_b64_tr_b16 v[72:73], v35 offset:2048
    ds_read_b64_tr_b16 v[74:75], v35 offset:2560
    ds_read_b64_tr_b16 v[76:77], v35 offset:3072
    ds_read_b64_tr_b16 v[78:79], v35 offset:3584
    s_waitcnt vmcnt(3) lgkmcnt(0)
    s_branch L_got_A
L_nan_B:
    v_max3_u32 v38, v64, v65, v66
    v_max3_u32 v38, v38, v67, v68
    v_max3_u32 v38, v38, v69, v70
    v_max3_u32 v38, v38, v71, v72
    v_max3_u32 v38, v38, v73, v74
    v_max3_u32 v38, v38, v75, v76
    v_max3_u32 v38, v38, v77, v78
    v_max_u32 v38, v38, v79
    v_cmp_eq_u32 vcc, -1, v38
    s_cbranch_vccz L_cont_B
    v_mov_b64 v[52:53], 0
    v_mov_b64 v[54:55], 0
    v_mov_b64 v[56:57], 0
    v_mov_b64 v[58:59], 0
L_retry_B:
    s_mov_b64 exec, vcc
    s_add_u32 s78, s39, 16384
    buffer_load_dwordx4 v[64:67], v22, s[44:47], s39 offen offset:0 sc1
    buffer_load_dwordx4 v[68:71], v22, s[44:47], s78 offen offset:0 sc1
    buffer_load_dwordx4 v[72:75], v22, s[44:47], s39 offen offset:256 sc1
    buffer_load_dwordx4 v[76:79], v22, s[44:47], s78 offen offset:256 sc1
    s_add_u32 s97, s97, 1
    s_cmp_gt_u32 s97, 400000
    s_cbranch_scc1 L_end
    s_waitcnt vmcnt(0)
    v_max3_u32 v38, v64, v65, v66
    v_max3_u32 v38, v38, v67, v68
    v_max3_u32 v38, v38, v69, v70
    v_max3_u32 v38, v38, v71, v72
    v_max3_u32 v38, v38, v73, v74
    v_max3_u32 v38, v38, v75, v76
    v_max3_u32 v38, v38, v77, v78
    v_max_u32 v38, v38, v79
    v_cmp_eq_u32 vcc, -1, v38
    s_cbranch_vccnz L_retry_B
    s_mov_b64 exec, -1
    s_branch L_wait_B
L_retry_R:
    s_add_u32 s97, s97, 1
    s_cmp_gt_u32 s97, 400000
    s_cbranch_scc1 L_end
    s_mov_b64 exec, vcc
    s_branch L_poll_R
L_nan_C:
    v_max3_u32 v51, v64, v65, v66
    v_max3_u32 v51, v51, v67, v68
    v_max3_u32 v51, v51, v69, v70
    v_max_u32 v51, v51, v71
    v_cmp_eq_u32 vcc, -1, v51
    s_cbranch_vccz L_cont_C
    v_mov_b64 v[36:37], 0
    v_mov_b64 v[38:39], 0
    v_mov_b64 v[40:41], 0
    v_mov_b64 v[42:43], 0
    v_mov_b64 v[44:45], 0
    v_mov_b64 v[46:47], 0
    v_mov_b64 v[48:49], 0
L_retry_C:
    s_mov_b64 exec, vcc
    buffer_load_dwordx4 v[64:67], v22, s[44:47], s39 offen sc1
    s_and_b64 exec, exec, s[82:83]
    s_cbranch_execz L_C_skip2
    buffer_load_dwordx4 v[68:71], v22, s[44:47], s39 offen offset:768 sc1
L_C_skip2:
    s_mov_b64 exec, vcc
    s_add_u32 s98, s98, 1
    s_cmp_gt_u32 s98, 400000
    s_cbranch_scc1 L_end
    s_waitcnt vmcnt(0)
    v_max3_u32 v51, v64, v65, v66
    v_max3_u32 v51, v51, v67, v68
    v_max3_u32 v51, v51, v69, v70
    v_max_u32 v51, v51, v71
    v_cmp_eq_u32 vcc, -1, v51
    s_cbranch_vccnz L_retry_C
    s_mov_b64 exec, -1
    s_branch L_got_C
L_int2:
    v_and_b32 v62, 124, v16
    global_load_dword v62, v62, s[28:29] sc1
    s_barrier
    s_add_u32 s83, s77, 98304
    buffer_load_dwordx4 v[96:99], v32, s[36:39], s83 offen offset:0 nt
    buffer_load_dwordx4 v[100:103], v32, s[36:39], s83 offen offset:1024 nt
    buffer_load_dwordx4 v[104:107], v32, s[36:39], s83 offen offset:2048 nt
    buffer_load_dwordx4 v[108:111], v32, s[36:39], s83 offen offset:3072 nt
    s_barrier
    s_add_u32 s83, s77, 114688
    buffer_load_dwordx4 v[112:115], v32, s[36:39], s83 offen offset:0 nt
    buffer_load_dwordx4 v[116:119], v32, s[36:39], s83 offen offset:1024 nt
    buffer_load_dwordx4 v[120:123], v32, s[36:39], s83 offen offset:2048 nt
    buffer_load_dwordx4 v[124:127], v32, s[36:39], s83 offen offset:3072 nt
    s_mov_b32 s71, 0x05040100
    s_mov_b32 s72, 0x07060302
    s_mov_b32 s40, 0x11111111
    s_mov_b32 s41, s40
    s_mov_b32 s32, 0x01010101
    s_mov_b32 s33, s32
    s_lshl_b32 s36, s2, 2
    s_add_u32 s36, s36, s3
    s_mov_b32 s38, 0
    v_and_b32 v38, 3, v0
    v_and_b32 v32, 0xf0, v16
    v_and_b32 v39, 0xe0, v16
    v_mad_u32_u24 v32, v39, 1, v32
    v_lshl_add_u32 v32, v38, 13, v32
    s_lshr_b32 s35, s4, 2
    s_xor_b32 s35, s35, 0
    s_lshl_b32 s35, s35, 13
    s_waitcnt vmcnt(17)
    v_perm_b32 v128, v140, v132, s71
    v_perm_b32 v136, v140, v132, s72
    v_perm_b32 v144, v141, v133, s71
    v_perm_b32 v152, v141, v133, s72
    v_perm_b32 v160, v142, v134, s71
    v_perm_b32 v168, v142, v134, s72
    v_perm_b32 v176, v143, v135, s71
    v_perm_b32 v184, v143, v135, s72
    v_perm_b32 v129, v156, v148, s71
    v_perm_b32 v137, v156, v148, s72
    v_perm_b32 v145, v157, v149, s71
    v_perm_b32 v153, v157, v149, s72
    v_perm_b32 v161, v158, v150, s71
    v_perm_b32 v169, v158, v150, s72
    v_perm_b32 v177, v159, v151, s71
    v_perm_b32 v185, v159, v151, s72
    v_perm_b32 v130, v172, v164, s71
    v_perm_b32 v138, v172, v164, s72
    v_perm_b32 v146, v173, v165, s71
    v_perm_b32 v154, v173, v165, s72
    v_perm_b32 v162, v174, v166, s71
    v_perm_b32 v170, v174, v166, s72
    v_perm_b32 v178, v175, v167, s71
    v_perm_b32 v186, v175, v167, s72
    v_perm_b32 v131, v188, v180, s71
    v_perm_b32 v139, v188, v180, s72
    v_perm_b32 v147, v189, v181, s71
    v_perm_b32 v155, v189, v181, s72
    v_perm_b32 v163, v190, v182, s71
    v_perm_b32 v171, v190, v182, s72
    v_perm_b32 v179, v191, v183, s71
    v_perm_b32 v187, v191, v183, s72
    v_perm_b32 v132, v200, v192, s71
    v_perm_b32 v140, v200, v192, s72
    v_perm_b32 v148, v201, v193, s71
    v_perm_b32 v156, v201, v193, s72
    v_perm_b32 v164, v202, v194, s71
    v_perm_b32 v172, v202, v194, s72
    v_perm_b32 v180, v203, v195, s71
    v_perm_b32 v188, v203, v195, s72
    v_perm_b32 v133, v216, v208, s71
    v_perm_b32 v141, v216, v208, s72
    v_perm_b32 v149, v217, v209, s71
    v_perm_b32 v157, v217, v209, s72
    v_perm_b32 v165, v218, v210, s71
    v_perm_b32 v173, v218, v210, s72
    v_perm_b32 v181, v219, v211, s71
    v_perm_b32 v189, v219, v211, s72
    v_perm_b32 v134, v232, v224, s71
    v_perm_b32 v142, v232, v224, s72
    v_perm_b32 v150, v233, v225, s71
    v_perm_b32 v158, v233, v225, s72
    v_perm_b32 v166, v234, v226, s71
    v_perm_b32 v174, v234, v226, s72
    v_perm_b32 v182, v235, v227, s71
    v_perm_b32 v190, v235, v227, s72
    v_perm_b32 v135, v248, v240, s71
    v_perm_b32 v143, v248, v240, s72
    v_perm_b32 v151, v249, v241, s71
    v_perm_b32 v159, v249, v241, s72
    v_perm_b32 v167, v250, v242, s71
    v_perm_b32 v175, v250, v242, s72
    v_perm_b32 v183, v251, v243, s71
    v_perm_b32 v191, v251, v243, s72
    s_and_b32 s80, s5, 3
    s_xor_b32 s80, s80, 0
    s_lshl_b32 s80, s80, 10
    s_add_u32 m0, s76, s80
    s_lshl_b32 s80, s80, 5
    buffer_load_dwordx4 v33, s[60:63], s80 offen lds
    s_cmp_ge_u32 s4, 6
    s_cbranch_scc1 L_pfG
    v_lshrrev_b32 v36, 3, v0
    v_and_b32 v37, 7, v0
    v_lshlrev_b32 v37, 7, v37
    v_min_u32 v37, 476, v37
    s_lshl_b32 s78, s5, 4
    s_and_b32 s79, s3, 1
    s_lshl_b32 s79, s79, 3
    s_add_u32 s78, s78, s79
    v_add_u32 v36, s78, v36
    s_movk_i32 s78, 2752
    v_mad_u32_u24 v36, v36, s78, v37
    s_mul_i32 s78, s4, 480
    s_cmp_ge_u32 s3, 2
    s_cbranch_scc1 L_pfU
    buffer_load_dword v63, v36, s[48:51], s78 offen
    s_branch L_pfD
L_pfU:
    buffer_load_dword v63, v36, s[52:55], s78 offen
    s_branch L_pfD
L_pfG:
    v_lshrrev_b32 v36, 2, v0
    v_min_u32 v36, 10, v36
    v_and_b32 v37, 3, v0
    v_lshlrev_b32 v37, 7, v37
    s_mul_i32 s78, s81, 11
    v_add_u32 v36, s78, v36
    v_lshl_add_u32 v36, v36, 10, v37
    s_sub_u32 s78, s4, 6
    s_lshl_b32 s78, s78, 9
    buffer_load_dword v63, v36, s[48:51], s78 offen
L_pfD:
    s_cmp_eq_u32 s7, 0
    s_branch L_PV
L_int3:
    s_waitcnt vmcnt(10)
L_flagchk:
    v_cmp_eq_u32 vcc, 0, v62
    s_cbranch_vccnz L_flagretry
    v_cmp_eq_u32 vcc, 1, v62
    s_nop 0
    s_bcnt1_i32_b64 s78, vcc
    v_cmp_eq_u32 vcc, 2, v62
    s_nop 0
    s_bcnt1_i32_b64 s79, vcc
    s_cmp_gt_u32 s79, s78
    s_cselect_b32 s78, 8192, 0
    s_xor_b32 s35, s35, s78
    s_mov_b32 s39, s35
    s_add_u32 s68, s68, s35
    s_add_u32 s69, s69, s35
    v_perm_b32 v192, v204, v196, s71
    v_perm_b32 v200, v204, v196, s72
    v_perm_b32 v208, v205, v197, s71
    v_perm_b32 v216, v205, v197, s72
    v_perm_b32 v224, v206, v198, s71
    v_perm_b32 v232, v206, v198, s72
    v_perm_b32 v240, v207, v199, s71
    v_perm_b32 v248, v207, v199, s72
    v_perm_b32 v193, v220, v212, s71
    v_perm_b32 v201, v220, v212, s72
    v_perm_b32 v209, v221, v213, s71
    v_perm_b32 v217, v221, v213, s72
    v_perm_b32 v225, v222, v214, s71
    v_perm_b32 v233, v222, v214, s72
    v_perm_b32 v241, v223, v215, s71
    v_perm_b32 v249, v223, v215, s72
    v_perm_b32 v194, v236, v228, s71
    v_perm_b32 v202, v236, v228, s72
    v_perm_b32 v210, v237, v229, s71
    v_perm_b32 v218, v237, v229, s72
    v_perm_b32 v226, v238, v230, s71
    v_perm_b32 v234, v238, v230, s72
    v_perm_b32 v242, v239, v231, s71
    v_perm_b32 v250, v239, v231, s72
    v_perm_b32 v195, v252, v244, s71
    v_perm_b32 v203, v252, v244, s72
    v_perm_b32 v211, v253, v245, s71
    v_perm_b32 v219, v253, v245, s72
    v_perm_b32 v227, v254, v246, s71
    v_perm_b32 v235, v254, v246, s72
    v_perm_b32 v243, v255, v247, s71
    v_perm_b32 v251, v255, v247, s72
    s_waitcnt vmcnt(8)
    v_perm_b32 v196, v100, v96, s71
    v_perm_b32 v204, v100, v96, s72
    v_perm_b32 v212, v101, v97, s71
    v_perm_b32 v220, v101, v97, s72
    v_perm_b32 v228, v102, v98, s71
    v_perm_b32 v236, v102, v98, s72
    v_perm_b32 v244, v103, v99, s71
    v_perm_b32 v252, v103, v99, s72
    s_waitcnt vmcnt(6)
    v_perm_b32 v197, v108, v104, s71
    v_perm_b32 v205, v108, v104, s72
    v_perm_b32 v213, v109, v105, s71
    v_perm_b32 v221, v109, v105, s72
    v_perm_b32 v229, v110, v106, s71
    v_perm_b32 v237, v110, v106, s72
    v_perm_b32 v245, v111, v107, s71
    v_perm_b32 v253, v111, v107, s72
    s_waitcnt vmcnt(4)
    v_perm_b32 v198, v116, v112, s71
    v_perm_b32 v206, v116, v112, s72
    v_perm_b32 v214, v117, v113, s71
    v_perm_b32 v222, v117, v113, s72
    v_perm_b32 v230, v118, v114, s71
    v_perm_b32 v238, v118, v114, s72
    v_perm_b32 v246, v119, v115, s71
    v_perm_b32 v254, v119, v115, s72
    s_waitcnt vmcnt(2)
    v_perm_b32 v199, v124, v120, s71
    v_perm_b32 v207, v124, v120, s72
    v_perm_b32 v215, v125, v121, s71
    v_perm_b32 v223, v125, v121, s72
    v_perm_b32 v231, v126, v122, s71
    v_perm_b32 v239, v126, v122, s72
    v_perm_b32 v247, v127, v123, s71
    v_perm_b32 v255, v127, v123, s72
    s_nop 0
    s_branch L_PV2
L_flagretry:
    s_add_u32 s96, s96, 1
    s_cmp_gt_u32 s96, 400000
    s_cbranch_scc1 L_end
    v_and_b32 v62, 124, v16
    global_load_dword v62, v62, s[28:29] sc1
    s_waitcnt vmcnt(0)
    s_branch L_flagchk
L_Wburst:
    s_barrier
    s_add_u32 m0, s82, 0
    s_mov_b32 s80, 0
    buffer_load_dwordx4 v47, s[40:43], s80 offen lds
    s_add_u32 m0, s82, 4096
    s_mov_b32 s80, 131072
    buffer_load_dwordx4 v47, s[40:43], s80 offen lds
    s_add_u32 m0, s82, 8192
    s_mov_b32 s80, 262144
    buffer_load_dwordx4 v47, s[40:43], s80 offen lds
    s_add_u32 m0, s82, 12288
    s_mov_b32 s80, 393216
    buffer_load_dwordx4 v47, s[40:43], s80 offen lds
    s_add_u32 m0, s82, 16384
    s_mov_b32 s80, 524288
    buffer_load_dwordx4 v47, s[40:43], s80 offen lds
    s_add_u32 m0, s82, 20480
    s_mov_b32 s80, 655360
    buffer_load_dwordx4 v47, s[40:43], s80 offen lds
    s_add_u32 m0, s82, 24576
    s_mov_b32 s80, 786432
    buffer_load_dwordx4 v47, s[40:43], s80 offen lds
    s_add_u32 m0, s82, 28672
    s_mov_b32 s80, 917504
    buffer_load_dwordx4 v47, s[40:43], s80 offen lds
    s_add_u32 m0, s82, 32768
    s_mov_b32 s80, 1048576
    buffer_load_dwordx4 v47, s[40:43], s80 offen lds
    s_add_u32 m0, s82, 36864
    s_mov_b32 s80, 1179648
    buffer_load_dwordx4 v47, s[40:43], s80 offen lds
    s_add_u32 m0, s82, 40960
    s_mov_b32 s80, 1310720
    buffer_load_dwordx4 v47, s[40:43], s80 offen lds
    s_add_u32 m0, s82, 45056
    s_mov_b32 s80, 1441792
    buffer_load_dwordx4 v47, s[40:43], s80 offen lds
    s_add_u32 m0, s82, 49152
    s_mov_b32 s80, 1572864
    buffer_load_dwordx4 v47, s[40:43], s80 offen lds
    s_add_u32 m0, s82, 53248
    s_mov_b32 s80, 1703936
    buffer_load_dwordx4 v47, s[40:43], s80 offen lds
    s_add_u32 m0, s82, 57344
    s_mov_b32 s80, 1835008
    buffer_load_dwordx4 v47, s[40:43], s80 offen lds
    s_add_u32 m0, s82, 61440
    s_mov_b32 s80, 1966080
    buffer_load_dwordx4 v47, s[40:43], s80 offen lds
    s_add_u32 m0, s82, 65536
    s_mov_b32 s80, 2097152
    buffer_load_dwordx4 v47, s[40:43], s80 offen lds
    s_add_u32 m0, s82, 69632
    s_mov_b32 s80, 2228224
    buffer_load_dwordx4 v47, s[40:43], s80 offen lds
    s_add_u32 m0, s82, 73728
    s_mov_b32 s80, 2359296
    buffer_load_dwordx4 v47, s[40:43], s80 offen lds
    s_add_u32 m0, s82, 77824
    s_mov_b32 s80, 2490368
    buffer_load_dwordx4 v47, s[40:43], s80 offen lds
    s_add_u32 m0, s82, 81920
    s_mov_b32 s80, 2621440
    buffer_load_dwordx4 v47, s[40:43], s80 offen lds
    s_add_u32 m0, s82, 86016
    s_mov_b32 s80, 2752512
    buffer_load_dwordx4 v47, s[40:43], s80 offen lds
    s_add_u32 m0, s82, 90112
    s_mov_b32 s80, 2883584
    buffer_load_dwordx4 v47, s[40:43], s80 offen lds
    s_add_u32 m0, s82, 94208
    s_mov_b32 s80, 3014656
    buffer_load_dwordx4 v47, s[40:43], s80 offen lds
    s_add_u32 m0, s82, 98304
    s_mov_b32 s80, 3145728
    buffer_load_dwordx4 v47, s[40:43], s80 offen lds
    s_add_u32 m0, s82, 102400
    s_mov_b32 s80, 3276800
    buffer_load_dwordx4 v47, s[40:43], s80 offen lds
    s_add_u32 m0, s82, 106496
    s_mov_b32 s80, 3407872
    buffer_load_dwordx4 v47, s[40:43], s80 offen lds
    s_add_u32 m0, s82, 110592
    s_mov_b32 s80, 3538944
    buffer_load_dwordx4 v47, s[40:43], s80 offen lds
    s_add_u32 m0, s82, 114688
    s_mov_b32 s80, 3670016
    buffer_load_dwordx4 v47, s[40:43], s80 offen lds
    s_add_u32 m0, s82, 118784
    s_mov_b32 s80, 3801088
    buffer_load_dwordx4 v47, s[40:43], s80 offen lds
    s_add_u32 m0, s82, 122880
    s_mov_b32 s80, 3932160
    buffer_load_dwordx4 v47, s[40:43], s80 offen lds
    s_add_u32 m0, s82, 126976
    s_mov_b32 s80, 4063232
    buffer_load_dwordx4 v47, s[40:43], s80 offen lds
L_ret:
    s_setpc_b64 s[0:1]
L_clear:
    s_cmp_eq_u32 s3, 0
    s_cbranch_scc0 L_start
    s_mov_b32 s44, s30
    s_mov_b32 s45, s31
    s_mov_b32 s46, 0xC0000
    s_mov_b32 s47, s35
    v_mov_b32 v52, -1
    v_mov_b32 v53, -1
    v_mov_b32 v54, -1
    v_mov_b32 v55, -1
    s_lshl_b32 s86, s2, 12
    buffer_store_dwordx4 v[52:55], v32, s[44:47], s86 offen offset:0 sc1
    buffer_store_dwordx4 v[52:55], v32, s[44:47], s86 offen offset:1024 sc1
    buffer_store_dwordx4 v[52:55], v32, s[44:47], s86 offen offset:2048 sc1
    buffer_store_dwordx4 v[52:55], v32, s[44:47], s86 offen offset:3072 sc1
    s_lshl_b32 s86, s2, 9
    s_add_u32 s86, s86, 131072
    v_add_u32 v56, s86, v32
    s_and_b32 s86, s2, 1
    s_lshl_b32 s86, s86, 8
    s_and_b32 s87, s2, 2
    s_lshl_b32 s87, s87, 13
    s_add_u32 s86, s86, s87
    s_add_u32 s86, s86, 153088
    s_cmp_lt_u32 s2, 4
    s_cselect_b32 s86, s86, s46
    v_and_b32 v57, 0xf0, v32
    v_and_b32 v58, 16, v0
    v_lshl_add_u32 v57, v58, 9, v57
    s_mov_b32 exec_lo, 0
    v_add_u32 v56, s86, v57
    s_mov_b32 exec_lo, -1
    buffer_store_dwordx4 v[52:55], v56, s[44:47], 0 offen sc1
    s_branch L_start
L_probe:
    s_cmp_eq_u32 s3, 3
    s_cbranch_scc0 L_probed
    s_lshl_b32 s82, s2, 7
    s_bfe_u32 s80, s2, 0x10003
    s_lshl_b32 s80, s80, 13
    s_add_u32 s82, s82, s80
    s_add_u32 s82, s82, 0x80000
    s_xor_b32 s80, s82, 8192
    s_load_dword s90, s[30:31], s82
    s_load_dwordx2 s[92:93], s[30:31], s80
    s_branch L_probed
L_flag:
    s_cmp_eq_u32 s3, 3
    s_cbranch_scc0 L_flagged
    s_lshl_b32 s80, s2, 2
    v_mov_b32 v42, s80
    s_bfe_u32 s71, s71, 0x20001
    s_lshr_b32 s78, s4, 2
    s_bfe_u32 s80, s2, 0x10003
    s_xor_b32 s78, s78, s80
    s_xor_b32 s78, s78, s71
    s_and_b32 s78, s78, 1
    s_add_u32 s78, s78, 1
    s_cmp_eq_u32 s71, 0
    s_cselect_b32 s78, 3, s78
    v_mov_b32 v41, s78
    s_mov_b64 exec, 1
    global_store_dword v42, v41, s[28:29] sc1
    s_mov_b64 exec, -1
    s_branch L_flagged
L_end:
    s_endpgm
.section .rodata,"a"
.p2align 6
.amdhsa_kernel interleave_layers__sliding_block_cached__geglu_ffn__decode_kernel
  .amdhsa_next_free_vgpr 512
  .amdhsa_next_free_sgpr 102
  .amdhsa_accum_offset 256
  .amdhsa_group_segment_fixed_size 0
  .amdhsa_kernarg_size 96
  .amdhsa_user_sgpr_count 2
  .amdhsa_user_sgpr_kernarg_segment_ptr 1
  .amdhsa_system_sgpr_workgroup_id_x 1
  .amdhsa_float_denorm_mode_32 3
.end_amdhsa_kernel
```
